```python
import torch

def _softmax(x, axis=-1):
    return torch.softmax(x, dim=axis)
def _gelu(x):
    return torch.nn.functional.gelu(x, approximate="tanh")
def _silu(x):
    return torch.nn.functional.silu(x)
def _sigmoid(x):
    return torch.sigmoid(x)
def _layernorm(x, axis=-1, eps=1e-5):
    m = x.mean(dim=axis, keepdim=True)
    v = x.var(dim=axis, keepdim=True, unbiased=False)
    return (x - m) / torch.sqrt(v + eps)
def _scatter_add(tgt, idx, src, axis=0):
    return tgt.clone().index_add_(axis, idx, src)
def _segment_sum(src, seg, n):
    out = torch.zeros((n,) + src.shape[1:], dtype=src.dtype)
    return out.index_add_(0, seg, src)
def _pad(x, pw):
    flat = tuple(v for pair in reversed(pw) for v in pair)
    return torch.nn.functional.pad(x, flat)

kernel_name = 'recurrent_scan__ssm_conv_s4d__mixer_channel_mlp__prompt'

def setup_inputs():

    _w = (lambda a: (lambda t: t.to(torch.bfloat16) if t.is_floating_point() else t)(torch.as_tensor(a)))
    def _A_setup():
        Bsz, L, D, N = 1, 2048, 512, 128
        return {
            "u": _w((lambda *s: torch.randn(*s, dtype=torch.bfloat16) * 0.05)(Bsz, L, D)),
            "log_A_real": _w((lambda *s: torch.randn(*s, dtype=torch.bfloat16) * 3.2)(D, N) * 0.5),
            "A_imag": _w((lambda *s: torch.randn(*s, dtype=torch.bfloat16) * 0.2)(D, N) * 3.14),
            "C_real": _w((lambda *s: torch.randn(*s, dtype=torch.bfloat16) * 0.8)(D, N) / N ** 0.5),
            "C_imag": _w((lambda *s: torch.randn(*s, dtype=torch.bfloat16) * 0.8)(D, N) / N ** 0.5),
            "log_dt": _w((lambda *s: torch.randn(*s, dtype=torch.bfloat16) * 0.2)(D) * 0.5 - 4.0),
            "D_skip": _w((lambda *s: torch.randn(*s, dtype=torch.bfloat16) * 0.2)(D)),
        }
    _A_in = _A_setup()

    def _B_setup():
        B, S, D, F = 1, 2048, 512, 1376
        return {
            "x": _w((lambda *s: torch.randn(*s, dtype=torch.bfloat16) * 0.05)(B, S, D)),
            "w1": _w((lambda *s: torch.randn(*s, dtype=torch.bfloat16) * 1.6)(D, F) * (D ** -0.5)),
            "b1": _w((lambda *s: torch.randn(*s, dtype=torch.bfloat16) * 0.8)(F)),
            "w2": _w((lambda *s: torch.randn(*s, dtype=torch.bfloat16) * 0.1)(F, D) * (F ** -0.5)),
            "b2": _w((lambda *s: torch.randn(*s, dtype=torch.bfloat16) * 0.1)(D)),
        }
    _B_in = _B_setup()

    return {
        "A_u": _A_in["u"],
        "A_log_A_real": _A_in["log_A_real"],
        "A_A_imag": _A_in["A_imag"],
        "A_C_real": _A_in["C_real"],
        "A_C_imag": _A_in["C_imag"],
        "A_log_dt": _A_in["log_dt"],
        "A_D_skip": _A_in["D_skip"],
        "B_x": _B_in["x"],
        "B_w1": _B_in["w1"],
        "B_b1": _B_in["b1"],
        "B_w2": _B_in["w2"],
        "B_b2": _B_in["b2"],
    }

def reference(A_u, A_log_A_real, A_A_imag, A_C_real, A_C_imag, A_log_dt, A_D_skip, B_x, B_w1, B_b1, B_w2, B_b2):
    def _A_ref(u, log_A_real, A_imag, C_real, C_imag, log_dt, D_skip):
        L = u.shape[1]
        dt = torch.exp(log_dt)
        A = -torch.exp(log_A_real) + 1j * A_imag
        C = (C_real + 1j * C_imag) * dt[:, None]
        pos = (lambda x, dt: x.to(dt))(torch.arange(L), log_dt.dtype)
        P = torch.exp((A * dt[:, None])[:, :, None] * pos[None, None, :])
        K = 2.0 * torch.einsum("dn,dnl->dl", C, P).real
        L2 = 2 * L
        u_t = (lambda x, *d: x.permute(*d))(u, 0, 2, 1)
        Kf = (lambda x, *a, **k: torch.fft.rfft(x.float(), *a, **k))(K, L2)
        Uf = (lambda x, *a, **k: torch.fft.rfft(x.float(), *a, **k))(u_t, L2)
        y = (lambda x, *a, **k: torch.fft.irfft(x, *a, **k).to(torch.bfloat16))(Uf * Kf[None, :, :], L2)[:, :, :L]
        y = (lambda x, *d: x.permute(*d))(y, 0, 2, 1)
        return y + u * D_skip[None, None, :]

    def _B_ref(x, w1, b1, w2, b2):
        y = _layernorm(x, axis=-1)
        h = _gelu(torch.einsum("bsd,df->bsf", y, w1) + b1)
        return torch.einsum("bsf,fd->bsd", h, w2) + b2

    x = A_u
    xn = _layernorm(x, axis=-1)
    s = _A_ref(xn, A_log_A_real, A_A_imag, A_C_real, A_C_imag, A_log_dt, A_D_skip)
    g = _silu(_B_ref(xn, B_w1, B_b1, B_w2, B_b2))
    return x + s * g
```

```asm
; @launch grid=(256,1,1) block=(512,1,1) lds=163840
.amdgcn_target "amdgcn-amd-amdhsa--gfx950"
.text
.globl recurrent_scan__ssm_conv_s4d__mixer_channel_mlp__prompt_kernel
.p2align 8
.type recurrent_scan__ssm_conv_s4d__mixer_channel_mlp__prompt_kernel,@function
recurrent_scan__ssm_conv_s4d__mixer_channel_mlp__prompt_kernel:
    s_load_dwordx16 s[4:19], s[0:1], 0
    s_load_dwordx8 s[20:27], s[0:1], 64
    s_load_dwordx4 s[28:31], s[0:1], 96
    s_load_dwordx2 s[32:33], s[0:1], 112
    s_cmp_ge_u32 s2, 256
    s_cbranch_scc1 Lend
    v_lshrrev_b32 v2, 6, v0
    v_and_b32 v1, 63, v0
    s_and_b32 s3, s2, 7
    v_readfirstlane_b32 s93, v2
    s_lshr_b32 s83, s2, 3
    s_getpc_b64 s[34:35]
Lpc:
    s_lshl_b32 s90, s83, 3
    s_add_u32 s90, s90, s93
    s_lshl_b32 s90, s90, 7
    s_min_u32 s90, s90, Lcodeend-Lpc-4
    v_mov_b32 v2, s90
    s_mov_b64 exec, 1
    global_load_dword v190, v2, s[34:35]
    s_mov_b64 exec, -1
    s_lshr_b32 s90, s83, 3
    s_and_b32 s64, s83, 7
    s_lshl_b32 s63, s3, 2
    s_add_u32 s63, s63, s90
    s_and_b32 s91, s3, 6
    s_lshl_b32 s61, s91, 1
    s_add_u32 s61, s61, s90
    s_and_b32 s92, s3, 1
    s_lshl_b32 s62, s92, 3
    s_add_u32 s62, s62, s64
    s_lshl_b32 s92, s92, 2
    s_xor_b32 s76, s91, s92
    s_and_b32 s60, s93, 3
    s_lshl_b32 s65, s60, 12
    s_mul_i32 s95, s60, 3072
    s_add_u32 s95, s95, 65536
    s_mov_b32 s50, 16777216
    s_mov_b32 s51, 0x20000
    s_mov_b32 s38, 2097152
    s_mov_b32 s39, 0x20000
    s_cmp_lt_u32 s93, 4
    s_cbranch_scc1 Lgemm
    s_lshl_b32 s66, s61, 17
    s_lshl_b32 s90, s60, 15
    s_add_u32 s66, s66, s90
    s_lshl_b32 s90, s76, 7
    s_add_u32 s66, s66, s90
    s_mul_i32 s67, s60, 44032
    s_mul_i32 s90, s62, 192
    s_add_u32 s67, s67, s90
    s_cmp_eq_u32 s62, 15
    s_cselect_b32 s66, 0x400000, s66
    s_cselect_b32 s67, 0x400000, s67
    v_lshrrev_b32 v45, 3, v1
    v_lshrrev_b32 v46, 4, v1
    v_and_b32 v47, 7, v1
    v_xor_b32 v48, v46, v47
    v_lshlrev_b32 v48, 4, v48
    v_lshl_add_u32 v2, v45, 10, v48
    v_xor_b32 v3, 64, v2
    v_add_u32 v3, 7168, v3
    s_movk_i32 s90, 2560
    s_lshl_b32 s92, s2, 9
    s_sub_u32 s92, s92, 512
    v_lshl_add_u32 v44, v0, 1, s92
    v_lshlrev_b32 v8, 4, v1
    v_add_u32 v48, 0, v1
    v_mul_u32_u24 v49, 171, v48
    v_lshrrev_b32 v49, 11, v49
    v_mad_u32_u24 v4, v49, s90, v8
    v_add_u32 v48, 64, v1
    v_mul_u32_u24 v49, 171, v48
    v_lshrrev_b32 v49, 11, v49
    v_mad_u32_u24 v5, v49, s90, v8
    v_add_u32 v48, 128, v1
    v_mul_u32_u24 v49, 171, v48
    v_lshrrev_b32 v49, 11, v49
    v_mad_u32_u24 v6, v49, s90, v8
    s_mov_b32 s42, 1409024
    s_mov_b32 s43, 0x20000
    s_lshl_b32 s91, s2, 2
    s_waitcnt lgkmcnt(0)
    global_load_short_d16_hi v40, v44, s[6:7]
    global_load_short_d16_hi v41, v44, s[8:9]
    global_load_short_d16_hi v42, v44, s[10:11]
    global_load_short_d16_hi v43, v44, s[12:13]
    s_load_dword s80, s[14:15], s91
    s_load_dword s81, s[16:17], s91
    s_mov_b64 s[36:37], s[4:5]
    s_mov_b64 s[40:41], s[20:21]
    s_xor_b32 s77, s66, 0
    s_add_u32 m0, s65, 0
    s_add_u32 s78, s77, 14336
    buffer_load_dwordx4 v2, s[36:39], s77 offen offset:0 lds
    buffer_load_dwordx4 v3, s[36:39], s77 offen offset:1024 lds
    buffer_load_dwordx4 v2, s[36:39], s78 offen offset:2048 lds
    buffer_load_dwordx4 v3, s[36:39], s78 offen offset:3072 lds
    s_xor_b32 s3, s76, 0
    s_mul_i32 s79, s3, 176128
    s_add_u32 m0, s95, 0
    s_add_u32 s79, s79, s67
    buffer_load_dwordx4 v4, s[40:43], s79 offen offset:0 lds
    buffer_load_dwordx4 v5, s[40:43], s79 offen offset:1024 lds
    buffer_load_dwordx4 v6, s[40:43], s79 offen offset:2048 lds
    s_lshl_b32 s90, s61, 17
    s_lshl_b32 s91, s60, 15
    s_add_u32 s90, s90, s91
    s_lshr_b32 s91, s90, 7
    s_add_u32 s70, s91, 65536
    s_lshr_b32 s91, s90, 9
    s_lshl_b32 s92, s62, 17
    s_add_u32 s91, s91, s92
    s_add_u32 s71, s91, 524288
    s_add_u32 s72, s71, 4096
    s_lshl_b32 s91, s62, 6
    s_add_u32 s73, s90, s91
    s_add_u32 s74, s73, 15360
    s_lshl_b32 s75, s62, 4
    s_add_u32 s75, s75, s61
    s_lshl_b32 s75, s75, 2
    s_add_u32 s75, s75, s60
    s_lshl_b32 s75, s75, 7
    s_add_u32 s75, s75, 393216
    s_lshr_b32 s90, s60, 1
    s_mul_i32 s90, s90, 9216
    s_mul_i32 s91, s60, 3072
    s_add_u32 s90, s90, s91
    s_add_u32 s18, s90, 123904
    v_lshrrev_b32 v48, 2, v1
    v_and_b32 v50, 3, v1
    v_lshlrev_b32 v49, 4, v50
    v_lshl_add_u32 v24, v48, 10, v49
    v_lshl_add_u32 v19, v48, 13, v49
    v_lshlrev_b32 v20, 6, v50
    v_lshlrev_b32 v49, 9, v50
    v_lshl_add_u32 v49, v48, 2, v49
    v_add_u32 v25, s18, v49
    s_mov_b64 s[48:49], s[32:33]
    s_mov_b32 s86, 0x3fb8aa3b
    s_lshr_b32 s35, s60, 1
    v_mov_b32 v9, 1
    v_and_b32 v48, 15, v1
    v_lshrrev_b32 v49, 5, v1
    v_and_b32 v50, 3, v1
    s_mul_i32 s92, s35, 15360
    s_add_u32 s92, s92, 114688
    s_and_b32 s93, s60, 1
    s_mul_i32 s90, s93, 4608
    s_add_u32 s90, s90, s92
    v_lshl_add_u32 v26, v1, 2, s90
    v_add_u32 v27, 1152, v26
    v_add_u32 v28, 2304, v26
    v_add_u32 v29, 3456, v26
    v_mul_u32_u24 v31, 288, v48
    v_lshl_add_u32 v31, v46, 4, v31
    v_add_u32 v31, s90, v31
    s_add_u32 s92, s92, 9216
    s_mul_i32 s90, s93, 3072
    s_add_u32 s90, s90, s92
    v_add_u32 v32, s90, v8
    s_xor_b32 s90, s93, 1
    s_mul_i32 s90, s90, 3072
    s_add_u32 s90, s90, s92
    v_add_u32 v33, s90, v8
    v_lshrrev_b32 v51, 3, v48
    v_bfe_u32 v52, v1, 2, 1
    v_lshl_add_u32 v51, v52, 3, v51
    v_sub_u32 v52, 3, v50
    v_lshl_add_u32 v51, v52, 1, v51
    v_lshlrev_b32 v51, 4, v51
    s_mul_i32 s90, s35, 2496
    s_add_u32 s90, s90, 157760
    v_sub_u32 v51, s90, v51
    v_and_b32 v52, 1, v46
    v_lshlrev_b32 v53, 8, v49
    v_lshl_add_u32 v53, v52, 3, v53
    v_sub_u32 v34, v51, v53
    v_add_u32 v34, 2100, v34
    v_lshlrev_b32 v53, 8, v52
    v_lshlrev_b32 v53, v49, v53
    v_mul_u32_u24 v54, 760, v49
    v_add_u32 v53, v53, v54
    v_sub_u32 v35, v51, v53
    v_add_u32 v35, 1576, v35
    s_mul_i32 s90, s35, 2496
    s_add_u32 s90, s90, 160056
    v_mul_u32_u24 v53, 160, v49
    v_lshlrev_b32 v54, 4, v48
    v_lshl_add_u32 v54, v52, 3, v54
    v_sub_u32 v53, v53, v54
    v_add_u32 v36, s90, v53
    v_lshlrev_b32 v51, 3, v46
    v_sub_u32 v51, v51, v48
    v_add_u32 v51, 16, v51
    s_mov_b32 s91, 0
    s_mov_b32 s90, 0xfe000000
    v_lshrrev_b64 v[52:53], v51, s[90:91]
    v_and_b32 v52, 0xff, v52
    v_lshl_or_b32 v52, v52, 15, v52
    v_and_b32 v54, 0x10001, v52
    v_mul_u32_u24 v10, 0x3f80, v54
    v_and_b32 v54, 0x40004, v52
    v_mul_u32_u24 v11, 0xfe0, v54
    v_and_b32 v54, 0x100010, v52
    v_mul_u32_u24 v12, 0x3f8, v54
    v_and_b32 v54, 0x400040, v52
    v_mul_u32_u24 v13, 0xfe, v54
    s_mov_b32 s90, 0x1ff0000
    v_lshrrev_b64 v[52:53], v51, s[90:91]
    v_and_b32 v52, 0xff, v52
    v_lshl_or_b32 v52, v52, 15, v52
    v_and_b32 v54, 0x10001, v52
    v_mul_u32_u24 v14, 0x3f80, v54
    v_and_b32 v54, 0x40004, v52
    v_mul_u32_u24 v15, 0xfe0, v54
    v_and_b32 v54, 0x100010, v52
    v_mul_u32_u24 v16, 0x3f8, v54
    v_and_b32 v54, 0x400040, v52
    v_mul_u32_u24 v17, 0xfe, v54
    v_lshrrev_b32 v52, 4, v1
    v_and_b32 v52, 1, v52
    v_lshlrev_b32 v52, 2, v52
    v_and_b32 v53, 7, v1
    v_xor_b32 v52, v52, v53
    v_lshlrev_b32 v52, 4, v52
    v_lshrrev_b32 v53, 3, v1
    v_lshl_add_u32 v7, v53, 10, v52
    s_mul_i32 s82, s60, 98304
    s_lshl_b32 s90, s64, 7
    s_add_u32 s82, s82, s90
    s_mov_b64 s[44:45], s[24:25]
    s_mov_b32 s46, 1409024
    s_mov_b32 s47, 0x20000
    s_mul_i32 s69, s35, 15360
    s_add_u32 s69, s69, 114688
    v_and_b32 v37, 15, v1
    v_lshrrev_b32 v38, 4, v1
    v_and_b32 v39, 3, v1
    v_lshrrev_b32 v30, 2, v37
    v_lshlrev_b32 v21, 1, v38
    v_sub_u32 v30, v21, v30
    v_lshrrev_b32 v21, 1, v39
    v_sub_u32 v30, v30, v21
    v_mul_u32_u24 v39, 264, v39
    v_add3_u32 v39, v39, v30, 4
    v_lshl_add_u32 v180, v39, 3, s69
    s_mul_i32 s93, s35, 1536
    s_add_u32 s93, s93, 146008
    v_and_b32 v39, 3, v1
    v_mul_u32_u24 v39, 192, v39
    v_lshrrev_b32 v30, 2, v37
    v_sub_u32 v30, v38, v30
    v_lshlrev_b32 v30, 3, v30
    v_sub_u32 v39, v30, v39
    v_add_u32 v181, s93, v39
    s_mul_i32 s90, s35, 4640
    s_add_u32 s90, s90, 148480
    v_lshl_add_u32 v39, v37, 1, v38
    v_lshl_add_u32 v182, v39, 4, s90
    s_and_b32 s91, s60, 1
    s_lshl_b32 s91, s91, 11
    s_add_u32 s19, s90, s91
    s_add_u32 s19, s19, 536
    v_lshlrev_b32 v39, 5, v37
    v_lshl_add_u32 v185, v38, 3, v39
    v_and_b32 v30, 1, v38
    v_lshrrev_b32 v38, 1, v38
    v_lshl_add_u32 v39, v38, 4, v39
    v_lshl_add_u32 v186, v30, 9, v39
    s_lshr_b32 s90, s2, 4
    s_lshl_b32 s90, s90, 13
    s_add_u32 s90, s90, 393216
    v_lshl_add_u32 v187, v1, 7, s90
    s_lshl_b32 s92, s2, 1
    s_add_u32 s92, s92, s35
    s_lshl_b32 s92, s92, 12
    s_add_u32 s88, s92, 2621440
    s_add_u32 s89, s92, 524288
    s_add_u32 s89, s89, s91
    s_lshl_b32 s68, s2, 7
    s_add_u32 s68, s68, 0
    s_lshl_b32 s90, s60, 2
    s_add_u32 s90, s90, 162752
    v_mov_b32 v22, s90
    s_xor_b32 s90, s90, 4
    v_mov_b32 v23, s90
    s_setprio 1
    s_xor_b32 s77, s66, 128
    s_add_u32 m0, s65, 16384
    s_add_u32 s78, s77, 14336
    buffer_load_dwordx4 v2, s[36:39], s77 offen offset:0 lds
    buffer_load_dwordx4 v3, s[36:39], s77 offen offset:1024 lds
    buffer_load_dwordx4 v2, s[36:39], s78 offen offset:2048 lds
    buffer_load_dwordx4 v3, s[36:39], s78 offen offset:3072 lds
    s_xor_b32 s3, s76, 1
    s_mul_i32 s79, s3, 176128
    s_add_u32 m0, s95, 12288
    s_add_u32 s79, s79, s67
    buffer_load_dwordx4 v4, s[40:43], s79 offen offset:0 lds
    buffer_load_dwordx4 v5, s[40:43], s79 offen offset:1024 lds
    buffer_load_dwordx4 v6, s[40:43], s79 offen offset:2048 lds
    s_mov_b32 m0, s18
    s_nop 0
    buffer_load_dwordx4 v24, s[36:39], s73 offen lds
    buffer_load_dwordx4 v24, s[36:39], s74 offen offset:1024 lds
    s_waitcnt vmcnt(16) lgkmcnt(0)
    s_lshl_b32 s90, s35, 4
    s_lshr_b32 s80, s80, s90
    s_lshl_b32 s80, s80, 16
    s_lshr_b32 s81, s81, s90
    s_lshl_b32 s81, s81, 16
    s_mov_b32 s91, 0x32a57060
    v_mov_b32 v44, s80
    v_mul_f32 v45, s86, v44
    v_mul_f32 v46, s86, v40
    v_fma_f32 v47, v44, s86, -v45
    v_fma_f32 v48, v40, s86, -v46
    v_exp_f32 v45, v45
    v_exp_f32 v46, v46
    v_fma_f32 v47, v44, s91, v47
    v_fma_f32 v48, v40, s91, v48
    v_mul_f32 v47, 0x3f317218, v47
    v_mul_f32 v48, 0x3f317218, v48
    v_fma_f32 v45, v45, v47, v45
    v_fma_f32 v46, v46, v48, v46
    v_cvt_pk_bf16_f32 v45, 0, v45
    v_cvt_pk_bf16_f32 v46, 0, v46
    v_mul_f32 v47, v41, v45
    v_mul_f32 v46, v46, v45
    v_add_f32 v44, v45, v45
    v_mul_f32 v47, 0.15915494, v47
    v_mul_f32 v46, 0xbfb8aa3b, v46
    v_mul_f32 v72, v42, v44
    v_mul_f32 v73, v43, v44
    v_mul_f32 v49, 0x41000000, v47
    v_mul_f32 v48, 0x41000000, v46
    v_fract_f32 v49, v49
    v_exp_f32 v48, v48
    v_sin_f32 v57, v49
    v_cos_f32 v56, v49
    v_mul_f32 v57, v57, v48
    v_mul_f32 v56, v56, v48
    v_sub_f32 v58, 0, v57
    v_fract_f32 v49, v47
    v_exp_f32 v48, v46
    v_sin_f32 v53, v49
    v_cos_f32 v52, v49
    v_mul_f32 v53, v53, v48
    v_mul_f32 v52, v52, v48
    v_sub_f32 v54, 0, v53
    v_mul_f32 v49, 0x43000000, v47
    v_mul_f32 v48, 0x43000000, v46
    v_fract_f32 v49, v49
    v_exp_f32 v48, v48
    v_sin_f32 v61, v49
    v_cos_f32 v60, v49
    v_mul_f32 v61, v61, v48
    v_mul_f32 v60, v60, v48
    v_sub_f32 v62, 0, v61
    v_mov_b32 v83, 0x3f80
    v_cvt_pk_bf16_f32 v91, v56, v57
    v_pk_mul_f32 v[138:139], v[56:57], v[56:57] op_sel:[0,0] op_sel_hi:[0,1]
    v_pk_fma_f32 v[138:139], v[56:57], v[56:57], v[138:139] op_sel:[1,1,0] op_sel_hi:[1,0,1] neg_lo:[0,1,0]
    v_cvt_pk_bf16_f32 v82, v138, v139
    v_pk_mul_f32 v[140:141], v[138:139], v[56:57] op_sel:[0,0] op_sel_hi:[0,1]
    v_pk_fma_f32 v[140:141], v[138:139], v[56:57], v[140:141] op_sel:[1,1,0] op_sel_hi:[1,0,1] neg_lo:[0,1,0]
    v_cvt_pk_bf16_f32 v90, v140, v141
    v_pk_mul_f32 v[138:139], v[140:141], v[56:57] op_sel:[0,0] op_sel_hi:[0,1]
    v_pk_fma_f32 v[138:139], v[140:141], v[56:57], v[138:139] op_sel:[1,1,0] op_sel_hi:[1,0,1] neg_lo:[0,1,0]
    v_cvt_pk_bf16_f32 v81, v138, v139
    v_pk_mul_f32 v[140:141], v[138:139], v[56:57] op_sel:[0,0] op_sel_hi:[0,1]
    v_pk_fma_f32 v[140:141], v[138:139], v[56:57], v[140:141] op_sel:[1,1,0] op_sel_hi:[1,0,1] neg_lo:[0,1,0]
    v_cvt_pk_bf16_f32 v89, v140, v141
    v_pk_mul_f32 v[138:139], v[140:141], v[56:57] op_sel:[0,0] op_sel_hi:[0,1]
    v_pk_fma_f32 v[138:139], v[140:141], v[56:57], v[138:139] op_sel:[1,1,0] op_sel_hi:[1,0,1] neg_lo:[0,1,0]
    v_cvt_pk_bf16_f32 v80, v138, v139
    v_pk_mul_f32 v[140:141], v[138:139], v[56:57] op_sel:[0,0] op_sel_hi:[0,1]
    v_pk_fma_f32 v[140:141], v[138:139], v[56:57], v[140:141] op_sel:[1,1,0] op_sel_hi:[1,0,1] neg_lo:[0,1,0]
    v_cvt_pk_bf16_f32 v88, v140, v141
    v_pk_mul_f32 v[138:139], v[140:141], v[56:57] op_sel:[0,0] op_sel_hi:[0,1]
    v_pk_fma_f32 v[138:139], v[140:141], v[56:57], v[138:139] op_sel:[1,1,0] op_sel_hi:[1,0,1] neg_lo:[0,1,0]
    v_cvt_pk_bf16_f32 v87, v138, v139
    v_pk_mul_f32 v[140:141], v[138:139], v[56:57] op_sel:[0,0] op_sel_hi:[0,1]
    v_pk_fma_f32 v[140:141], v[138:139], v[56:57], v[140:141] op_sel:[1,1,0] op_sel_hi:[1,0,1] neg_lo:[0,1,0]
    v_cvt_pk_bf16_f32 v95, v140, v141
    v_pk_mul_f32 v[138:139], v[140:141], v[56:57] op_sel:[0,0] op_sel_hi:[0,1]
    v_pk_fma_f32 v[138:139], v[140:141], v[56:57], v[138:139] op_sel:[1,1,0] op_sel_hi:[1,0,1] neg_lo:[0,1,0]
    v_cvt_pk_bf16_f32 v86, v138, v139
    v_pk_mul_f32 v[140:141], v[138:139], v[56:57] op_sel:[0,0] op_sel_hi:[0,1]
    v_pk_fma_f32 v[140:141], v[138:139], v[56:57], v[140:141] op_sel:[1,1,0] op_sel_hi:[1,0,1] neg_lo:[0,1,0]
    v_cvt_pk_bf16_f32 v94, v140, v141
    v_pk_mul_f32 v[138:139], v[140:141], v[56:57] op_sel:[0,0] op_sel_hi:[0,1]
    v_pk_fma_f32 v[138:139], v[140:141], v[56:57], v[138:139] op_sel:[1,1,0] op_sel_hi:[1,0,1] neg_lo:[0,1,0]
    v_cvt_pk_bf16_f32 v85, v138, v139
    v_pk_mul_f32 v[140:141], v[138:139], v[56:57] op_sel:[0,0] op_sel_hi:[0,1]
    v_pk_fma_f32 v[140:141], v[138:139], v[56:57], v[140:141] op_sel:[1,1,0] op_sel_hi:[1,0,1] neg_lo:[0,1,0]
    v_cvt_pk_bf16_f32 v93, v140, v141
    v_pk_mul_f32 v[138:139], v[140:141], v[56:57] op_sel:[0,0] op_sel_hi:[0,1]
    v_pk_fma_f32 v[138:139], v[140:141], v[56:57], v[138:139] op_sel:[1,1,0] op_sel_hi:[1,0,1] neg_lo:[0,1,0]
    v_cvt_pk_bf16_f32 v84, v138, v139
    v_pk_mul_f32 v[140:141], v[138:139], v[56:57] op_sel:[0,0] op_sel_hi:[0,1]
    v_pk_fma_f32 v[140:141], v[138:139], v[56:57], v[140:141] op_sel:[1,1,0] op_sel_hi:[1,0,1] neg_lo:[0,1,0]
    v_cvt_pk_bf16_f32 v92, v140, v141
    v_pk_mul_f32 v[64:65], v[52:53], v[52:53] op_sel:[0,0] op_sel_hi:[0,1]
    v_pk_fma_f32 v[64:65], v[52:53], v[52:53], v[64:65] op_sel:[1,1,0] op_sel_hi:[1,0,1] neg_lo:[0,1,0]
    v_sub_f32 v66, 0, v65
    v_pk_mul_f32 v[74:75], v[72:73], v[60:61] op_sel:[0,0] op_sel_hi:[0,1]
    v_pk_fma_f32 v[74:75], v[72:73], v[60:61], v[74:75] op_sel:[1,1,0] op_sel_hi:[1,0,1] neg_lo:[0,1,0]
    v_pk_mul_f32 v[68:69], v[64:65], v[64:65] op_sel:[0,0] op_sel_hi:[0,1]
    v_pk_fma_f32 v[68:69], v[64:65], v[64:65], v[68:69] op_sel:[1,1,0] op_sel_hi:[1,0,1] neg_lo:[0,1,0]
    v_sub_f32 v70, 0, v69
    v_cvt_pk_bf16_f32 v99, v72, -v73
    v_pk_mul_f32 v[138:139], v[72:73], v[52:53] op_sel:[0,0] op_sel_hi:[0,1]
    v_pk_fma_f32 v[138:139], v[72:73], v[52:53], v[138:139] op_sel:[1,1,0] op_sel_hi:[1,0,1] neg_lo:[0,1,0]
    v_cvt_pk_bf16_f32 v98, v138, -v139
    v_pk_mul_f32 v[140:141], v[138:139], v[52:53] op_sel:[0,0] op_sel_hi:[0,1]
    v_pk_fma_f32 v[140:141], v[138:139], v[52:53], v[140:141] op_sel:[1,1,0] op_sel_hi:[1,0,1] neg_lo:[0,1,0]
    v_cvt_pk_bf16_f32 v97, v140, -v141
    v_pk_mul_f32 v[138:139], v[140:141], v[52:53] op_sel:[0,0] op_sel_hi:[0,1]
    v_pk_fma_f32 v[138:139], v[140:141], v[52:53], v[138:139] op_sel:[1,1,0] op_sel_hi:[1,0,1] neg_lo:[0,1,0]
    v_cvt_pk_bf16_f32 v96, v138, -v139
    v_pk_mul_f32 v[140:141], v[138:139], v[52:53] op_sel:[0,0] op_sel_hi:[0,1]
    v_pk_fma_f32 v[140:141], v[138:139], v[52:53], v[140:141] op_sel:[1,1,0] op_sel_hi:[1,0,1] neg_lo:[0,1,0]
    v_cvt_pk_bf16_f32 v103, v140, -v141
    v_pk_mul_f32 v[138:139], v[140:141], v[52:53] op_sel:[0,0] op_sel_hi:[0,1]
    v_pk_fma_f32 v[138:139], v[140:141], v[52:53], v[138:139] op_sel:[1,1,0] op_sel_hi:[1,0,1] neg_lo:[0,1,0]
    v_cvt_pk_bf16_f32 v102, v138, -v139
    v_pk_mul_f32 v[140:141], v[138:139], v[52:53] op_sel:[0,0] op_sel_hi:[0,1]
    v_pk_fma_f32 v[140:141], v[138:139], v[52:53], v[140:141] op_sel:[1,1,0] op_sel_hi:[1,0,1] neg_lo:[0,1,0]
    v_cvt_pk_bf16_f32 v101, v140, -v141
    v_pk_mul_f32 v[138:139], v[140:141], v[52:53] op_sel:[0,0] op_sel_hi:[0,1]
    v_pk_fma_f32 v[138:139], v[140:141], v[52:53], v[138:139] op_sel:[1,1,0] op_sel_hi:[1,0,1] neg_lo:[0,1,0]
    v_cvt_pk_bf16_f32 v100, v138, -v139
    s_waitcnt vmcnt(9)
    s_barrier
    ds_read_b32 v18, v22 offset:160
    v_cvt_pk_bf16_f32 v107, v74, -v75
    v_mul_f32 v138, v74, v52
    v_mul_f32 v139, v74, v53
    v_fmac_f32 v138, v75, v54
    v_fmac_f32 v139, v75, v52
    s_xor_b32 s77, s66, 256
    s_add_u32 m0, s65, 32768
    s_add_u32 s78, s77, 14336
    buffer_load_dwordx4 v2, s[36:39], s77 offen offset:0 lds
    v_cvt_pk_bf16_f32 v106, v138, -v139
    v_mul_f32 v140, v138, v52
    v_mul_f32 v141, v138, v53
    v_fmac_f32 v140, v139, v54
    v_fmac_f32 v141, v139, v52
    buffer_load_dwordx4 v3, s[36:39], s77 offen offset:1024 lds
    v_cvt_pk_bf16_f32 v105, v140, -v141
    v_mul_f32 v138, v140, v52
    v_mul_f32 v139, v140, v53
    v_fmac_f32 v138, v141, v54
    v_fmac_f32 v139, v141, v52
    buffer_load_dwordx4 v2, s[36:39], s78 offen offset:2048 lds
    v_cvt_pk_bf16_f32 v104, v138, -v139
    v_mul_f32 v140, v138, v52
    v_mul_f32 v141, v138, v53
    v_fmac_f32 v140, v139, v54
    v_fmac_f32 v141, v139, v52
    buffer_load_dwordx4 v3, s[36:39], s78 offen offset:3072 lds
    v_cvt_pk_bf16_f32 v111, v140, -v141
    v_mul_f32 v138, v140, v52
    v_mul_f32 v139, v140, v53
    v_fmac_f32 v138, v141, v54
    v_fmac_f32 v139, v141, v52
    s_xor_b32 s3, s76, 2
    s_mul_i32 s79, s3, 176128
    s_add_u32 m0, s95, 24576
    s_add_u32 s79, s79, s67
    buffer_load_dwordx4 v4, s[40:43], s79 offen offset:0 lds
    v_cvt_pk_bf16_f32 v110, v138, -v139
    v_mul_f32 v140, v138, v52
    v_mul_f32 v141, v138, v53
    v_fmac_f32 v140, v139, v54
    v_fmac_f32 v141, v139, v52
    buffer_load_dwordx4 v5, s[40:43], s79 offen offset:1024 lds
    v_cvt_pk_bf16_f32 v109, v140, -v141
    v_mul_f32 v138, v140, v52
    v_mul_f32 v139, v140, v53
    v_fmac_f32 v138, v141, v54
    v_fmac_f32 v139, v141, v52
    buffer_load_dwordx4 v6, s[40:43], s79 offen offset:2048 lds
    v_cvt_pk_bf16_f32 v108, v138, -v139
    v_mul_f32 v76, v74, v60
    v_mul_f32 v77, v74, v61
    v_fmac_f32 v76, v75, v62
    v_fmac_f32 v77, v75, v60
    v_mul_f32 v138, v76, v64
    v_mul_f32 v139, v76, v65
    v_fmac_f32 v138, v77, v66
    s_waitcnt vmcnt(9)
    s_barrier
    s_waitcnt vmcnt(7)
    ds_read_b32 v144, v25 offset:0
    ds_read_b32 v145, v25 offset:64
    ds_read_b32 v146, v25 offset:128
    ds_read_b32 v147, v25 offset:192
    ds_read_b32 v148, v25 offset:256
    ds_read_b32 v149, v25 offset:320
    s_xor_b32 s77, s66, 384
    s_add_u32 m0, s65, 49152
    s_add_u32 s78, s77, 14336
    buffer_load_dwordx4 v2, s[36:39], s77 offen offset:0 lds
    ds_read_b32 v150, v25 offset:384
    ds_read_b32 v151, v25 offset:448
    v_fmac_f32 v139, v77, v64
    v_cvt_pk_bf16_f32 v115, v138, -v139
    v_mul_f32 v140, v138, v64
    v_mul_f32 v141, v138, v65
    buffer_load_dwordx4 v3, s[36:39], s77 offen offset:1024 lds
    v_fmac_f32 v140, v139, v66
    v_fmac_f32 v141, v139, v64
    v_cvt_pk_bf16_f32 v114, v140, -v141
    v_mul_f32 v138, v140, v64
    v_mul_f32 v139, v140, v65
    v_fmac_f32 v138, v141, v66
    v_fmac_f32 v139, v141, v64
    buffer_load_dwordx4 v2, s[36:39], s78 offen offset:2048 lds
    v_cvt_pk_bf16_f32 v113, v138, -v139
    v_mul_f32 v140, v138, v64
    v_mul_f32 v141, v138, v65
    v_fmac_f32 v140, v139, v66
    v_fmac_f32 v141, v139, v64
    v_cvt_pk_bf16_f32 v112, v140, -v141
    buffer_load_dwordx4 v3, s[36:39], s78 offen offset:3072 lds
    v_mul_f32 v72, v76, v60
    v_mul_f32 v73, v76, v61
    v_fmac_f32 v72, v77, v62
    v_fmac_f32 v73, v77, v60
    v_mul_f32 v138, v72, v64
    v_mul_f32 v139, v72, v65
    v_fmac_f32 v138, v73, v66
    s_xor_b32 s3, s76, 3
    s_mul_i32 s79, s3, 176128
    s_add_u32 m0, s95, 36864
    s_add_u32 s79, s79, s67
    buffer_load_dwordx4 v4, s[40:43], s79 offen offset:0 lds
    v_fmac_f32 v139, v73, v64
    v_cvt_pk_bf16_f32 v119, v138, -v139
    v_mul_f32 v140, v138, v64
    v_mul_f32 v141, v138, v65
    v_fmac_f32 v140, v139, v66
    v_fmac_f32 v141, v139, v64
    buffer_load_dwordx4 v5, s[40:43], s79 offen offset:1024 lds
    v_cvt_pk_bf16_f32 v118, v140, -v141
    v_mul_f32 v138, v140, v64
    v_mul_f32 v139, v140, v65
    v_fmac_f32 v138, v141, v66
    v_fmac_f32 v139, v141, v64
    v_cvt_pk_bf16_f32 v117, v138, -v139
    buffer_load_dwordx4 v6, s[40:43], s79 offen offset:2048 lds
    v_mul_f32 v140, v138, v64
    v_mul_f32 v141, v138, v65
    v_fmac_f32 v140, v139, v66
    v_fmac_f32 v141, v139, v64
    v_cvt_pk_bf16_f32 v116, v140, -v141
    v_mul_f32 v74, v72, v60
    v_mul_f32 v75, v72, v61
    v_fmac_f32 v74, v73, v62
    s_waitcnt vmcnt(7)
    s_barrier
    v_fmac_f32 v75, v73, v60
    v_cvt_pk_bf16_f32 v121, v74, -v75
    v_mul_f32 v138, v74, v68
    v_mul_f32 v139, v74, v69
    s_xor_b32 s77, s66, 512
    s_add_u32 m0, s65, 0
    s_add_u32 s78, s77, 14336
    buffer_load_dwordx4 v2, s[36:39], s77 offen offset:0 lds
    v_fmac_f32 v138, v75, v70
    v_fmac_f32 v139, v75, v68
    v_cvt_pk_bf16_f32 v120, v138, -v139
    buffer_load_dwordx4 v3, s[36:39], s77 offen offset:1024 lds
    v_mul_f32 v72, v74, v60
    v_mul_f32 v73, v74, v61
    v_fmac_f32 v72, v75, v62
    buffer_load_dwordx4 v2, s[36:39], s78 offen offset:2048 lds
    v_fmac_f32 v73, v75, v60
    v_cvt_pk_bf16_f32 v123, v72, -v73
    v_mul_f32 v138, v72, v68
    buffer_load_dwordx4 v3, s[36:39], s78 offen offset:3072 lds
    v_mul_f32 v139, v72, v69
    v_fmac_f32 v138, v73, v70
    v_fmac_f32 v139, v73, v68
    s_xor_b32 s3, s76, 4
    s_mul_i32 s79, s3, 176128
    s_add_u32 m0, s95, 0
    s_add_u32 s79, s79, s67
    buffer_load_dwordx4 v4, s[40:43], s79 offen offset:0 lds
    v_cvt_pk_bf16_f32 v122, v138, -v139
    v_mul_f32 v74, v72, v60
    v_mul_f32 v75, v72, v61
    v_fmac_f32 v74, v73, v62
    buffer_load_dwordx4 v5, s[40:43], s79 offen offset:1024 lds
    v_fmac_f32 v75, v73, v60
    v_cvt_pk_bf16_f32 v125, v74, -v75
    v_mul_f32 v138, v74, v68
    buffer_load_dwordx4 v6, s[40:43], s79 offen offset:2048 lds
    v_mul_f32 v139, v74, v69
    v_fmac_f32 v138, v75, v70
    v_fmac_f32 v139, v75, v68
    buffer_load_dwordx4 v[160:163], v20, s[48:51], s70 offen offset:0 sc1
    v_cvt_pk_bf16_f32 v124, v138, -v139
    v_mul_f32 v72, v74, v60
    v_mul_f32 v73, v74, v61
    buffer_load_dwordx4 v[164:167], v20, s[48:51], s70 offen offset:16 sc1
    v_fmac_f32 v72, v75, v62
    v_fmac_f32 v73, v75, v60
    v_cvt_pk_bf16_f32 v127, v72, -v73
    buffer_load_dwordx4 v[168:171], v20, s[48:51], s70 offen offset:32 sc1
    v_mul_f32 v138, v72, v68
    v_mul_f32 v139, v72, v69
    v_fmac_f32 v138, v73, v70
    buffer_load_dwordx4 v[172:175], v20, s[48:51], s70 offen offset:48 sc1
    v_fmac_f32 v139, v73, v68
    v_cvt_pk_bf16_f32 v126, v138, -v139
    v_mul_f32 v74, v72, v60
    v_mul_f32 v75, v72, v61
    v_fmac_f32 v74, v73, v62
    v_fmac_f32 v75, v73, v60
    v_cvt_pk_bf16_f32 v136, v74, -v75
    v_cvt_pk_bf16_f32 v137, v76, -v77
    s_waitcnt vmcnt(11)
    s_barrier
    v_mul_f32 v138, v74, v56
    v_mul_f32 v139, v74, v57
    v_fmac_f32 v138, v75, v58
    v_fmac_f32 v139, v75, v56
    v_cvt_pk_bf16_f32 v128, v138, -v139
    v_mul_f32 v140, v138, v60
    s_xor_b32 s77, s66, 640
    s_add_u32 m0, s65, 16384
    s_add_u32 s78, s77, 14336
    buffer_load_dwordx4 v2, s[36:39], s77 offen offset:0 lds
    v_mul_f32 v141, v138, v61
    v_fmac_f32 v140, v139, v62
    v_fmac_f32 v141, v139, v60
    v_cvt_pk_bf16_f32 v129, v140, -v141
    v_mul_f32 v138, v140, v60
    buffer_load_dwordx4 v3, s[36:39], s77 offen offset:1024 lds
    v_mul_f32 v139, v140, v61
    v_fmac_f32 v138, v141, v62
    v_fmac_f32 v139, v141, v60
    v_cvt_pk_bf16_f32 v130, v138, -v139
    v_mul_f32 v140, v138, v60
    buffer_load_dwordx4 v2, s[36:39], s78 offen offset:2048 lds
    v_mul_f32 v141, v138, v61
    v_fmac_f32 v140, v139, v62
    v_fmac_f32 v141, v139, v60
    v_cvt_pk_bf16_f32 v131, v140, -v141
    v_mul_f32 v138, v140, v60
    buffer_load_dwordx4 v3, s[36:39], s78 offen offset:3072 lds
    v_mul_f32 v139, v140, v61
    v_fmac_f32 v138, v141, v62
    v_fmac_f32 v139, v141, v60
    v_cvt_pk_bf16_f32 v132, v138, -v139
    v_mul_f32 v140, v138, v60
    s_xor_b32 s3, s76, 5
    s_mul_i32 s79, s3, 176128
    s_add_u32 m0, s95, 12288
    s_add_u32 s79, s79, s67
    buffer_load_dwordx4 v4, s[40:43], s79 offen offset:0 lds
    v_mul_f32 v141, v138, v61
    v_fmac_f32 v140, v139, v62
    v_fmac_f32 v141, v139, v60
    v_cvt_pk_bf16_f32 v133, v140, -v141
    v_mul_f32 v138, v140, v60
    buffer_load_dwordx4 v5, s[40:43], s79 offen offset:1024 lds
    v_mul_f32 v139, v140, v61
    v_fmac_f32 v138, v141, v62
    v_fmac_f32 v139, v141, v60
    v_cvt_pk_bf16_f32 v134, v138, -v139
    v_mul_f32 v140, v138, v60
    buffer_load_dwordx4 v6, s[40:43], s79 offen offset:2048 lds
    v_mul_f32 v141, v138, v61
    v_fmac_f32 v140, v139, v62
    v_fmac_f32 v141, v139, v60
    v_cvt_pk_bf16_f32 v135, v140, -v141
    v_cmp_eq_u32 vcc, 3, v1
    v_mov_b32 v44, s81
    s_nop 0
    v_cndmask_b32 v44, 0, v44, vcc
    s_waitcnt vmcnt(11)
    s_barrier
    s_waitcnt vmcnt(7) lgkmcnt(0)
    v_xor_b32 v152, v163, v18
    v_xor_b32 v153, v167, v18
    v_or_b32 v152, v152, v153
    v_xor_b32 v153, v171, v18
    v_or_b32 v152, v152, v153
    v_xor_b32 v153, v175, v18
    v_or_b32 v152, v152, v153
    v_cmp_ne_u32 vcc, 0, v152
    s_mov_b32 s87, 0
    s_cmp_eq_u64 vcc, 0
    s_cbranch_scc1 Lok_1
Lspin_2:
    buffer_load_dwordx4 v[160:163], v20, s[48:51], s70 offen offset:0 sc1
    buffer_load_dwordx4 v[164:167], v20, s[48:51], s70 offen offset:16 sc1
    buffer_load_dwordx4 v[168:171], v20, s[48:51], s70 offen offset:32 sc1
    buffer_load_dwordx4 v[172:175], v20, s[48:51], s70 offen offset:48 sc1
    s_add_u32 s87, s87, 1
    s_waitcnt vmcnt(0)
    v_xor_b32 v152, v163, v18
    v_xor_b32 v153, v167, v18
    v_or_b32 v152, v152, v153
    v_xor_b32 v153, v171, v18
    v_or_b32 v152, v152, v153
    v_xor_b32 v153, v175, v18
    v_or_b32 v152, v152, v153
    v_cmp_ne_u32 vcc, 0, v152
    s_cmp_gt_u32 s87, 262144
    s_cbranch_scc1 Lok_1
    s_cmp_eq_u64 vcc, 0
    s_cbranch_scc0 Lspin_2
Lok_1:
    v_and_b32 v163, 0xffff0000, v160
    v_lshlrev_b32 v160, 16, v160
    s_xor_b32 s77, s66, 768
    s_add_u32 m0, s65, 32768
    s_add_u32 s78, s77, 14336
    buffer_load_dwordx4 v2, s[36:39], s77 offen offset:0 lds
    v_lshlrev_b32 v152, 16, v144
    v_and_b32 v144, 0xffff0000, v144
    v_sub_f32 v152, v152, v160
    v_sub_f32 v144, v144, v160
    v_cvt_pk_bf16_f32 v152, 0, v152
    buffer_load_dwordx4 v3, s[36:39], s77 offen offset:1024 lds
    v_cvt_pk_bf16_f32 v144, 0, v144
    v_mul_f32 v152, v152, v161
    v_mul_f32 v144, v144, v161
    v_lshlrev_b32 v153, 16, v145
    v_and_b32 v145, 0xffff0000, v145
    buffer_load_dwordx4 v2, s[36:39], s78 offen offset:2048 lds
    v_sub_f32 v153, v153, v163
    v_sub_f32 v145, v145, v163
    v_cvt_pk_bf16_f32 v153, 0, v153
    v_cvt_pk_bf16_f32 v145, 0, v145
    v_mul_f32 v153, v153, v162
    buffer_load_dwordx4 v3, s[36:39], s78 offen offset:3072 lds
    v_mul_f32 v145, v145, v162
    v_cvt_pk_bf16_f32 v40, v152, v153
    v_cvt_pk_bf16_f32 v176, v144, v145
    v_and_b32 v167, 0xffff0000, v164
    v_lshlrev_b32 v164, 16, v164
    s_xor_b32 s3, s76, 6
    s_mul_i32 s79, s3, 176128
    s_add_u32 m0, s95, 24576
    s_add_u32 s79, s79, s67
    buffer_load_dwordx4 v4, s[40:43], s79 offen offset:0 lds
    v_lshlrev_b32 v152, 16, v146
    v_and_b32 v146, 0xffff0000, v146
    v_sub_f32 v152, v152, v164
    v_sub_f32 v146, v146, v164
    v_cvt_pk_bf16_f32 v152, 0, v152
    buffer_load_dwordx4 v5, s[40:43], s79 offen offset:1024 lds
    v_cvt_pk_bf16_f32 v146, 0, v146
    v_mul_f32 v152, v152, v165
    v_mul_f32 v146, v146, v165
    v_lshlrev_b32 v153, 16, v147
    buffer_load_dwordx4 v6, s[40:43], s79 offen offset:2048 lds
    v_and_b32 v147, 0xffff0000, v147
    v_sub_f32 v153, v153, v167
    v_sub_f32 v147, v147, v167
    v_cvt_pk_bf16_f32 v153, 0, v153
    v_cvt_pk_bf16_f32 v147, 0, v147
    v_mul_f32 v153, v153, v166
    v_mul_f32 v147, v147, v166
    v_cvt_pk_bf16_f32 v41, v152, v153
    s_waitcnt vmcnt(7)
    s_barrier
    v_cvt_pk_bf16_f32 v177, v146, v147
    v_and_b32 v171, 0xffff0000, v168
    v_lshlrev_b32 v168, 16, v168
    v_lshlrev_b32 v152, 16, v148
    v_and_b32 v148, 0xffff0000, v148
    s_xor_b32 s77, s66, 896
    s_add_u32 m0, s65, 49152
    s_add_u32 s78, s77, 14336
    buffer_load_dwordx4 v2, s[36:39], s77 offen offset:0 lds
    v_sub_f32 v152, v152, v168
    v_sub_f32 v148, v148, v168
    v_cvt_pk_bf16_f32 v152, 0, v152
    v_cvt_pk_bf16_f32 v148, 0, v148
    v_mul_f32 v152, v152, v169
    buffer_load_dwordx4 v3, s[36:39], s77 offen offset:1024 lds
    v_mul_f32 v148, v148, v169
    v_lshlrev_b32 v153, 16, v149
    v_and_b32 v149, 0xffff0000, v149
    v_sub_f32 v153, v153, v171
    v_sub_f32 v149, v149, v171
    buffer_load_dwordx4 v2, s[36:39], s78 offen offset:2048 lds
    v_cvt_pk_bf16_f32 v153, 0, v153
    v_cvt_pk_bf16_f32 v149, 0, v149
    v_mul_f32 v153, v153, v170
    v_mul_f32 v149, v149, v170
    v_cvt_pk_bf16_f32 v42, v152, v153
    buffer_load_dwordx4 v3, s[36:39], s78 offen offset:3072 lds
    v_cvt_pk_bf16_f32 v178, v148, v149
    v_and_b32 v175, 0xffff0000, v172
    v_lshlrev_b32 v172, 16, v172
    v_lshlrev_b32 v152, 16, v150
    v_and_b32 v150, 0xffff0000, v150
    s_xor_b32 s3, s76, 7
    s_mul_i32 s79, s3, 176128
    s_add_u32 m0, s95, 36864
    s_add_u32 s79, s79, s67
    buffer_load_dwordx4 v4, s[40:43], s79 offen offset:0 lds
    v_sub_f32 v152, v152, v172
    v_sub_f32 v150, v150, v172
    v_cvt_pk_bf16_f32 v152, 0, v152
    v_cvt_pk_bf16_f32 v150, 0, v150
    v_mul_f32 v152, v152, v173
    buffer_load_dwordx4 v5, s[40:43], s79 offen offset:1024 lds
    v_mul_f32 v150, v150, v173
    v_lshlrev_b32 v153, 16, v151
    v_and_b32 v151, 0xffff0000, v151
    v_sub_f32 v153, v153, v175
    v_sub_f32 v151, v151, v175
    buffer_load_dwordx4 v6, s[40:43], s79 offen offset:2048 lds
    v_cvt_pk_bf16_f32 v153, 0, v153
    v_cvt_pk_bf16_f32 v151, 0, v151
    v_mul_f32 v153, v153, v174
    v_mul_f32 v151, v151, v174
    v_cvt_pk_bf16_f32 v43, v152, v153
    v_cvt_pk_bf16_f32 v179, v150, v151
    buffer_store_dwordx4 v[40:43], v19, s[48:51], s71 offen sc1
    buffer_store_dwordx4 v[176:179], v19, s[48:51], s72 offen sc1
    s_waitcnt vmcnt(9)
    s_barrier
    s_add_u32 m0, s65, 0
    s_add_u32 s83, s82, 0
    buffer_load_dwordx4 v7, s[44:47], s83 offen offset:0 lds
    s_add_u32 s83, s82, 7168
    buffer_load_dwordx4 v7, s[44:47], s83 offen offset:1024 lds
    s_add_u32 s83, s82, 391168
    buffer_load_dwordx4 v7, s[44:47], s83 offen offset:2048 lds
    s_add_u32 s83, s82, 398336
    buffer_load_dwordx4 v7, s[44:47], s83 offen offset:3072 lds
    s_add_u32 m0, s95, 0
    s_add_u32 s83, s82, 786432
    buffer_load_dwordx4 v7, s[44:47], s83 offen offset:0 lds
    s_add_u32 s83, s82, 793600
    buffer_load_dwordx4 v7, s[44:47], s83 offen offset:1024 lds
    s_add_u32 s83, s82, 1177600
    s_cmp_ge_u32 s60, 3
    s_cselect_b32 s101, 4293509120, 0
    s_add_u32 s83, s83, s101
    buffer_load_dwordx4 v7, s[44:47], s83 offen offset:2048 lds
    s_add_u32 m0, s65, 16384
    s_add_u32 s83, s82, 1187840
    s_cmp_ge_u32 s60, 3
    s_cselect_b32 s101, 4293509120, 0
    s_add_u32 s83, s83, s101
    buffer_load_dwordx4 v7, s[44:47], s83 offen offset:0 lds
    s_add_u32 s83, s82, 113664
    buffer_load_dwordx4 v7, s[44:47], s83 offen offset:1024 lds
    s_add_u32 s83, s82, 120832
    buffer_load_dwordx4 v7, s[44:47], s83 offen offset:2048 lds
    s_waitcnt vmcnt(12)
    s_waitcnt vmcnt(10)
    s_mov_b64 exec, 1
    buffer_store_dword v18, off, s[48:51], s75 sc1
    s_mov_b64 exec, -1
    s_barrier
    s_add_u32 s83, s82, 504832
    buffer_load_dwordx4 v7, s[44:47], s83 offen offset:3072 lds
    s_add_u32 m0, s95, 12288
    s_add_u32 s83, s82, 516096
    buffer_load_dwordx4 v7, s[44:47], s83 offen offset:0 lds
    s_barrier
    s_add_u32 s83, s82, 900096
    buffer_load_dwordx4 v7, s[44:47], s83 offen offset:1024 lds
    s_add_u32 s83, s82, 907264
    buffer_load_dwordx4 v7, s[44:47], s83 offen offset:2048 lds
    s_add_u32 m0, s65, 32768
    s_add_u32 s83, s82, 1294336
    s_cmp_ge_u32 s60, 2
    s_cselect_b32 s101, 4293509120, 0
    s_add_u32 s83, s83, s101
    buffer_load_dwordx4 v7, s[44:47], s83 offen offset:0 lds
    s_add_u32 s83, s82, 1301504
    s_cmp_ge_u32 s60, 2
    s_cselect_b32 s101, 4293509120, 0
    s_add_u32 s83, s83, s101
    buffer_load_dwordx4 v7, s[44:47], s83 offen offset:1024 lds
    s_add_u32 s83, s82, 227328
    buffer_load_dwordx4 v7, s[44:47], s83 offen offset:2048 lds
    s_add_u32 s83, s82, 234496
    buffer_load_dwordx4 v7, s[44:47], s83 offen offset:3072 lds
    s_add_u32 m0, s95, 24576
    s_add_u32 s83, s82, 622592
    buffer_load_dwordx4 v7, s[44:47], s83 offen offset:0 lds
    s_add_u32 s83, s82, 629760
    buffer_load_dwordx4 v7, s[44:47], s83 offen offset:1024 lds
    s_add_u32 s83, s82, 1013760
    buffer_load_dwordx4 v7, s[44:47], s83 offen offset:2048 lds
    s_add_u32 m0, s65, 49152
    s_add_u32 s83, s82, 1024000
    buffer_load_dwordx4 v7, s[44:47], s83 offen offset:0 lds
    s_add_u32 s83, s82, 48128
    buffer_load_dwordx4 v7, s[44:47], s83 offen offset:1024 lds
    s_add_u32 s83, s82, 55296
    buffer_load_dwordx4 v7, s[44:47], s83 offen offset:2048 lds
    s_add_u32 s83, s82, 439296
    buffer_load_dwordx4 v7, s[44:47], s83 offen offset:3072 lds
    s_add_u32 m0, s95, 36864
    s_add_u32 s83, s82, 450560
    buffer_load_dwordx4 v7, s[44:47], s83 offen offset:0 lds
    s_add_u32 s83, s82, 834560
    buffer_load_dwordx4 v7, s[44:47], s83 offen offset:1024 lds
    s_add_u32 s83, s82, 841728
    buffer_load_dwordx4 v7, s[44:47], s83 offen offset:2048 lds
    ds_write2_b32 v26, v80, v81 offset0:0 offset1:72
    ds_write2_b32 v26, v82, v83 offset0:144 offset1:216
    ds_write2_b32 v27, v84, v85 offset0:0 offset1:72
    ds_write2_b32 v27, v86, v87 offset0:144 offset1:216
    ds_write2_b32 v28, v88, v89 offset0:0 offset1:72
    ds_write2_b32 v28, v90, v91 offset0:144 offset1:216
    ds_write2_b32 v29, v92, v93 offset0:0 offset1:72
    ds_write2_b32 v29, v94, v95 offset0:144 offset1:216
    ds_read_b128 v[144:147], v31 offset:0
    ds_read_b128 v[148:151], v31 offset:64
    ds_read_b128 v[152:155], v31 offset:128
    ds_read_b128 v[156:159], v31 offset:192
    ds_write2_b32 v26, v96, v97 offset0:0 offset1:72
    ds_write2_b32 v26, v98, v99 offset0:144 offset1:216
    ds_write2_b32 v27, v100, v101 offset0:0 offset1:72
    ds_write2_b32 v27, v102, v103 offset0:144 offset1:216
    ds_write2_b32 v28, v104, v105 offset0:0 offset1:72
    ds_write2_b32 v28, v106, v107 offset0:144 offset1:216
    ds_write2_b32 v29, v108, v109 offset0:0 offset1:72
    ds_write2_b32 v29, v110, v111 offset0:144 offset1:216
    ds_read_b128 v[48:51], v31 offset:0
    ds_read_b128 v[52:55], v31 offset:64
    ds_read_b128 v[56:59], v31 offset:128
    ds_read_b128 v[60:63], v31 offset:192
    ds_write2_b32 v26, v112, v113 offset0:0 offset1:72
    ds_write2_b32 v26, v114, v115 offset0:144 offset1:216
    ds_write2_b32 v27, v116, v117 offset0:0 offset1:72
    ds_write2_b32 v27, v118, v119 offset0:144 offset1:216
    ds_write2_b32 v28, v120, v121 offset0:0 offset1:72
    ds_write2_b32 v28, v122, v123 offset0:144 offset1:216
    s_waitcnt vmcnt(0)
    ds_write_b32 v22, v9 offset:32
    s_cmp_eq_u32 s60, 0
    s_cselect_b32 s90, 0, 268435456
    buffer_load_dword v188, v187, s[48:51], s90 offen sc1
    ds_write2_b32 v29, v124, v125 offset0:0 offset1:72
    ds_write2_b32 v29, v126, v127 offset0:144 offset1:216
    ds_read_b128 v[160:163], v31 offset:0
    ds_read_b128 v[164:167], v31 offset:64
    ds_read_b128 v[168:171], v31 offset:128
    ds_read_b128 v[172:175], v31 offset:192
    s_waitcnt lgkmcnt(13)
    v_mfma_f32_16x16x32_bf16 a[0:3], v[48:51], v[144:147], 0
    v_mfma_f32_16x16x32_bf16 a[0:3], v[52:55], v[148:151], a[0:3]
    v_mfma_f32_16x16x32_bf16 a[0:3], v[56:59], v[152:155], a[0:3]
    v_mfma_f32_16x16x32_bf16 a[0:3], v[60:63], v[156:159], a[0:3]
    ds_write2_b32 v26, v128, v129 offset0:0 offset1:72
    ds_write2_b32 v26, v130, v131 offset0:144 offset1:216
    ds_write2_b32 v27, v132, v133 offset0:0 offset1:72
    ds_write2_b32 v27, v134, v135 offset0:144 offset1:216
    ds_write2_b32 v28, v136, v137 offset0:0 offset1:72
    ds_read_b128 v[48:51], v31 offset:0
    ds_read_b128 v[52:55], v31 offset:64
    ds_read_b128 v[56:59], v31 offset:128
    ds_read_b128 v[60:63], v31 offset:192
    s_waitcnt lgkmcnt(9)
    v_mfma_f32_16x16x32_bf16 a[4:7], v[160:163], v[144:147], 0
    v_mfma_f32_16x16x32_bf16 a[4:7], v[164:167], v[148:151], a[4:7]
    v_mfma_f32_16x16x32_bf16 a[4:7], v[168:171], v[152:155], a[4:7]
    v_mfma_f32_16x16x32_bf16 a[4:7], v[172:175], v[156:159], a[4:7]
    s_waitcnt lgkmcnt(0)
    v_mfma_f32_16x16x32_bf16 a[8:11], v[144:147], v[48:51], 0
    v_mfma_f32_16x16x32_bf16 a[8:11], v[148:151], v[52:55], a[8:11]
    v_mfma_f32_16x16x32_bf16 a[8:11], v[152:155], v[56:59], a[8:11]
    v_mfma_f32_16x16x32_bf16 a[8:11], v[156:159], v[60:63], a[8:11]
    ds_write_b128 v32, a[0:3] offset:0
    s_nop 1
    ds_write_b128 v32, a[4:7] offset:1024
    s_nop 3
    ds_write_b128 v32, a[8:11] offset:2048
    s_waitcnt lgkmcnt(0)
    ds_write_b32 v22, v9 offset:48
Llw_3:
    ds_read_b32 v77, v23 offset:48
    s_waitcnt lgkmcnt(0)
    v_cmp_eq_u32 vcc, 1, v77
    s_cbranch_vccz Llw_3
    s_bitcmp1_b32 s60, 0
    s_cbranch_scc1 Lk_odd
    ds_read_b128 v[80:83], v33
    ds_read_b128 v[84:87], v32
    ds_read_b128 v[88:91], v33 offset:2048
    ds_read_b128 v[92:95], v32 offset:2048
    s_waitcnt lgkmcnt(2)
    v_add_f32 v83, v83, v44
    v_add_f32 v80, v80, v84
    v_add_f32 v81, v81, v85
    v_add_f32 v82, v82, v86
    v_add_f32 v83, v83, v87
    v_cvt_pk_bf16_f32 v80, v80, v81
    v_cvt_pk_bf16_f32 v81, v82, v83
    ds_write2_b32 v34, v80, v81 offset1:1
    s_waitcnt lgkmcnt(1)
    v_add_f32 v88, v88, v92
    v_add_f32 v89, v89, v93
    v_add_f32 v90, v90, v94
    v_add_f32 v91, v91, v95
    s_mul_i32 s90, s35, 2496
    s_add_u32 s90, s90, 157760
    v_mov_b32 v100, s90
    v_cvt_pk_bf16_f32 v88, v88, v89
    v_cvt_pk_bf16_f32 v89, v90, v91
    v_cvt_pk_bf16_f32 v96, 0, v91
    v_cvt_pk_bf16_f32 v97, v91, v91
    v_cvt_pk_bf16_f32 v98, v91, v91
    v_cvt_pk_bf16_f32 v99, v91, v91
    s_mov_b32 exec_lo, 0x00ff00ff
    s_mov_b32 exec_hi, 0x00ff00ff
    ds_write_b64 v36, v[88:89]
    s_mov_b64 exec, 0x100
    ds_write_b128 v100, v[96:99] offset:48
    s_mov_b64 exec, 0x200
    ds_write_b32 v100, v97 offset:1592
    s_mov_b64 exec, -1
    s_branch Lk_done
Lk_odd:
    ds_read_b128 v[80:83], v33 offset:1024
    ds_read_b128 v[84:87], v32 offset:1024
    s_waitcnt lgkmcnt(0)
    v_add_f32 v80, v80, v84
    v_add_f32 v81, v81, v85
    v_add_f32 v82, v82, v86
    v_add_f32 v83, v83, v87
    v_cvt_pk_bf16_f32 v88, v80, v80
    v_cvt_pk_bf16_f32 v89, v80, v81
    v_cvt_pk_bf16_f32 v90, v81, v81
    v_cvt_pk_bf16_f32 v91, v81, v81
    v_cvt_pk_bf16_f32 v92, v82, v82
    v_cvt_pk_bf16_f32 v93, v82, v83
    v_cvt_pk_bf16_f32 v94, v83, v83
    v_cvt_pk_bf16_f32 v95, v83, v83
    s_mov_b32 exec_lo, 0
    ds_write_b128 v35, v[88:91] offset:256
    ds_write_b128 v35, v[92:95]
    s_mov_b32 exec_lo, -1
    s_mov_b32 exec_hi, 0
    ds_write2_b64 v35, v[88:89], v[92:93] offset1:1
    s_mov_b64 exec, -1
Lk_done:
    v_mov_b32 v189, 162752
    s_cmp_eq_u32 s60, 0
    s_cbranch_scc0 Loth_4
    s_waitcnt vmcnt(0)
    v_cmp_ne_u32 vcc, v18, v188
    s_mov_b32 s87, 0
    s_cmp_eq_u64 vcc, 0
    s_cbranch_scc1 Lok_6
Lspin_7:
    buffer_load_dword v188, v187, s[48:51], 0 offen sc1
    s_add_u32 s87, s87, 1
    s_waitcnt vmcnt(0)
    v_cmp_ne_u32 vcc, v18, v188
    s_cmp_gt_u32 s87, 262144
    s_cbranch_scc1 Lok_6
    s_cmp_eq_u64 vcc, 0
    s_cbranch_scc0 Lspin_7
Lok_6:
    ds_write_b32 v189, v9 offset:128
    s_waitcnt lgkmcnt(0)
    s_branch Lsp_5
Loth_4:
Llw_8:
    ds_read_b32 v188, v189 offset:128
    s_waitcnt lgkmcnt(0)
    v_cmp_eq_u32 vcc, 1, v188
    s_cbranch_vccz Llw_8
Lsp_5:
    s_mov_b32 m0, s19
    s_nop 0
    buffer_load_dwordx4 v8, s[48:51], s89 offen sc1 lds
    buffer_load_dwordx4 v8, s[48:51], s89 offen offset:1024 sc1 lds
    ds_write_b32 v22, v9 offset:64
Llw_9:
    ds_read_b32 v77, v23 offset:64
    s_waitcnt lgkmcnt(0)
    v_cmp_eq_u32 vcc, 1, v77
    s_cbranch_vccz Llw_9
    s_and_b32 s92, s60, 1
    s_lshl_b32 s93, s92, 10
    s_mul_i32 s90, s35, 2496
    s_add_u32 s90, s90, 157808
    s_add_u32 s3, s90, s93
    v_add_u32 v44, s3, v8
    ds_read_b128 v[80:83], v44
    ds_read_b64 v[84:85], v44 offset:16
    s_add_u32 s3, s69, s93
    s_add_u32 s3, s3, 48
    v_add_u32 v45, s3, v8
    s_cmp_eq_u32 s92, 1
    s_cbranch_scc1 Lp_odd
    v_lshrrev_b32 v110, 2, v1
    v_and_b32 v111, 3, v1
    v_cmp_lt_u32 vcc, 2, v110
    v_add_u32 v112, 128, v110
    s_sub_u32 s90, s90, 48
    v_cndmask_b32 v110, v110, v112, vcc
    v_lshlrev_b32 v110, 4, v110
    v_lshl_add_u32 v112, v111, 1, v110
    v_add_u32 v112, s90, v112
    s_mov_b64 exec, 0xffffff
    ds_read_b128 v[106:109], v112
    v_sub_u32 v111, 1, v111
    v_and_b32 v111, 3, v111
    v_mul_u32_u24 v111, 2112, v111
    v_add3_u32 v110, v110, v111, s69
    s_waitcnt lgkmcnt(0)
    ds_write_b128 v110, v[106:109]
    s_mov_b64 exec, -1
    s_branch Lp_done
Lp_odd:
    s_mul_i32 s90, s35, 2496
    s_add_u32 s90, s90, 159936
    s_mul_i32 s93, s35, 1536
    s_add_u32 s93, s93, 145408
    v_lshrrev_b32 v110, 5, v1
    v_and_b32 v111, 31, v1
    v_lshlrev_b32 v111, 3, v111
    v_mul_u32_u24 v112, 160, v110
    v_add3_u32 v112, v112, v111, s90
    v_mul_u32_u24 v110, 768, v110
    v_add3_u32 v110, v110, v111, s93
    s_mov_b32 exec_lo, 0x7ffff
    s_mov_b32 exec_hi, 0x7ffff
    ds_read2_b64 v[106:109], v112 offset1:1
    s_waitcnt lgkmcnt(0)
    v_alignbit_b32 v114, v107, v106, 16
    v_alignbit_b32 v115, v108, v107, 16
    v_mov_b32 v116, v107
    v_mov_b32 v117, v108
    v_alignbit_b32 v118, v108, v107, 16
    v_alignbit_b32 v119, v109, v108, 16
    ds_write_b64 v110, v[106:107]
    ds_write_b64 v110, v[114:115] offset:192
    ds_write_b64 v110, v[116:117] offset:384
    ds_write_b64 v110, v[118:119] offset:576
    s_mov_b64 exec, -1
Lp_done:
    ds_write_b128 v45, v[80:83] offset:2112
    v_alignbit_b32 v88, v81, v80, 16
    v_alignbit_b32 v89, v82, v81, 16
    v_alignbit_b32 v90, v83, v82, 16
    v_alignbit_b32 v91, v84, v83, 16
    ds_write_b128 v45, v[88:91]
    v_mov_b32 v92, v81
    v_mov_b32 v93, v82
    v_mov_b32 v94, v83
    v_mov_b32 v95, v84
    ds_write_b128 v45, v[92:95] offset:6336
    v_alignbit_b32 v96, v82, v81, 16
    v_alignbit_b32 v97, v83, v82, 16
    v_alignbit_b32 v98, v84, v83, 16
    v_alignbit_b32 v99, v85, v84, 16
    ds_write_b128 v45, v[96:99] offset:4224
    s_waitcnt vmcnt(0)
    s_waitcnt lgkmcnt(0)
    ds_write_b32 v22, v9 offset:80
Llw_10:
    ds_read_b32 v77, v23 offset:80
    s_waitcnt lgkmcnt(0)
    v_cmp_eq_u32 vcc, 1, v77
    s_cbranch_vccz Llw_10
    ds_read_b64 a[0:1], v180 offset:2048
    ds_read_b64 a[2:3], v180 offset:2056
    ds_read_b64 a[4:5], v180 offset:1984
    ds_read_b64 a[6:7], v180 offset:1992
    ds_read_b64 a[8:9], v180 offset:1920
    ds_read_b64 a[10:11], v180 offset:1928
    ds_read_b64 a[12:13], v180 offset:1856
    ds_read_b64 a[14:15], v180 offset:1864
    ds_read_b64 a[16:17], v180 offset:1792
    ds_read_b64 a[18:19], v180 offset:1800
    ds_read_b64 a[20:21], v180 offset:1728
    ds_read_b64 a[22:23], v180 offset:1736
    ds_read_b64 a[24:25], v180 offset:1664
    ds_read_b64 a[26:27], v180 offset:1672
    ds_read_b64 a[28:29], v180 offset:1600
    ds_read_b64 a[30:31], v180 offset:1608
    ds_read_b64 a[32:33], v180 offset:1536
    ds_read_b64 a[34:35], v180 offset:1544
    ds_read_b64 a[36:37], v180 offset:1472
    ds_read_b64 a[38:39], v180 offset:1480
    ds_read_b64 a[40:41], v180 offset:1408
    ds_read_b64 a[42:43], v180 offset:1416
    ds_read_b64 a[44:45], v180 offset:1344
    ds_read_b64 a[46:47], v180 offset:1352
    ds_read_b64 a[48:49], v180 offset:1280
    ds_read_b64 a[50:51], v180 offset:1288
    ds_read_b64 a[52:53], v180 offset:1216
    ds_read_b64 a[54:55], v180 offset:1224
    ds_read_b64 a[56:57], v180 offset:1152
    ds_read_b64 a[58:59], v180 offset:1160
    ds_read_b64 a[60:61], v180 offset:1088
    ds_read_b64 a[62:63], v180 offset:1096
    ds_read_b64 v[40:41], v180 offset:1024
    ds_read_b64 v[42:43], v180 offset:1032
    ds_read_b64 v[44:45], v180 offset:960
    ds_read_b64 v[46:47], v180 offset:968
    ds_read_b64 v[48:49], v180 offset:896
    ds_read_b64 v[50:51], v180 offset:904
    ds_read_b64 v[52:53], v180 offset:832
    ds_read_b64 v[54:55], v180 offset:840
    ds_read_b64 v[56:57], v180 offset:768
    ds_read_b64 v[58:59], v180 offset:776
    ds_read_b64 v[60:61], v180 offset:704
    ds_read_b64 v[62:63], v180 offset:712
    ds_read_b64 v[64:65], v180 offset:640
    ds_read_b64 v[66:67], v180 offset:648
    ds_read_b64 v[68:69], v180 offset:576
    ds_read_b64 v[70:71], v180 offset:584
    ds_read_b64 v[72:73], v180 offset:512
    ds_read_b64 v[74:75], v180 offset:520
    ds_read_b64 v[76:77], v180 offset:448
    ds_read_b64 v[78:79], v180 offset:456
    ds_read_b64 v[80:81], v180 offset:384
    ds_read_b64 v[82:83], v180 offset:392
    ds_read_b64 v[84:85], v180 offset:320
    ds_read_b64 v[86:87], v180 offset:328
    ds_read_b64 v[88:89], v180 offset:256
    ds_read_b64 v[90:91], v180 offset:264
    ds_read_b64 v[92:93], v180 offset:192
    ds_read_b64 v[94:95], v180 offset:200
    ds_read_b64 v[96:97], v180 offset:128
    ds_read_b64 v[98:99], v180 offset:136
    ds_read_b64 v[100:101], v180 offset:64
    ds_read_b64 v[102:103], v180 offset:72
    ds_read_b64 v[104:105], v180 offset:0
    ds_read_b64 v[106:107], v180 offset:8
    ds_read_b64 v[108:109], v181 offset:96
    ds_read_b64 v[110:111], v181 offset:864
    ds_read_b64 v[112:113], v181 offset:64
    ds_read_b64 v[114:115], v181 offset:832
    ds_read_b64 v[116:117], v181 offset:32
    ds_read_b64 v[118:119], v181 offset:800
    ds_read_b64 v[120:121], v181 offset:0
    ds_read_b64 v[122:123], v181 offset:768
    s_bitcmp1_b32 s60, 0
    s_cbranch_scc1 Lc_odd
    ds_read_b128 v[124:127], v182 offset:496
    ds_read_b128 v[144:147], v182 offset:2560
    ds_read_b128 v[148:151], v182 offset:2496
    ds_read_b128 v[152:155], v182 offset:2432
    ds_read_b128 v[156:159], v182 offset:2368
    s_waitcnt lgkmcnt(4)
    v_mfma_f32_16x16x32_bf16 v[30:33], v[124:127], v[10:13], 0
    v_mfma_f32_16x16x32_bf16 v[34:37], v[124:127], v[14:17], 0
    s_waitcnt lgkmcnt(3)
    v_mfma_f32_16x16x32_bf16 v[140:143], a[0:3], v[144:147], 0
    ds_read_b128 v[160:163], v182 offset:2304
    s_waitcnt lgkmcnt(3)
    v_mfma_f32_16x16x32_bf16 v[140:143], a[4:7], v[148:151], v[140:143]
    ds_read_b128 v[144:147], v182 offset:2240
    s_waitcnt lgkmcnt(3)
    v_mfma_f32_16x16x32_bf16 v[140:143], a[8:11], v[152:155], v[140:143]
    ds_read_b128 v[148:151], v182 offset:2176
    s_waitcnt lgkmcnt(3)
    v_mfma_f32_16x16x32_bf16 v[140:143], a[12:15], v[156:159], v[140:143]
    ds_read_b128 v[152:155], v182 offset:2112
    s_waitcnt lgkmcnt(3)
    v_mfma_f32_16x16x32_bf16 v[140:143], a[16:19], v[160:163], v[140:143]
    ds_read_b128 v[156:159], v182 offset:2048
    s_waitcnt lgkmcnt(3)
    v_mfma_f32_16x16x32_bf16 v[140:143], a[20:23], v[144:147], v[140:143]
    ds_read_b128 v[160:163], v182 offset:1984
    s_waitcnt lgkmcnt(3)
    v_mfma_f32_16x16x32_bf16 v[140:143], a[24:27], v[148:151], v[140:143]
    ds_read_b128 v[144:147], v182 offset:1920
    s_waitcnt lgkmcnt(3)
    v_mfma_f32_16x16x32_bf16 v[140:143], a[28:31], v[152:155], v[140:143]
    ds_read_b128 v[148:151], v182 offset:1856
    s_waitcnt lgkmcnt(3)
    v_mfma_f32_16x16x32_bf16 v[136:139], a[0:3], v[156:159], 0
    ds_read_b128 v[152:155], v182 offset:1792
    v_mfma_f32_16x16x32_bf16 v[140:143], a[32:35], v[156:159], v[140:143]
    v_cvt_pk_bf16_f32 v30, v30, v31
    s_waitcnt lgkmcnt(3)
    v_mfma_f32_16x16x32_bf16 v[136:139], a[4:7], v[160:163], v[136:139]
    ds_read_b128 v[156:159], v182 offset:1728
    v_cvt_pk_bf16_f32 v31, v32, v33
    v_mfma_f32_16x16x32_bf16 v[140:143], a[36:39], v[160:163], v[140:143]
    v_cvt_pk_bf16_f32 v32, v34, v35
    s_waitcnt lgkmcnt(3)
    v_mfma_f32_16x16x32_bf16 v[136:139], a[8:11], v[144:147], v[136:139]
    ds_read_b128 v[160:163], v182 offset:1664
    v_cvt_pk_bf16_f32 v33, v36, v37
    v_mfma_f32_16x16x32_bf16 v[140:143], a[40:43], v[144:147], v[140:143]
    s_waitcnt lgkmcnt(3)
    v_mfma_f32_16x16x32_bf16 v[136:139], a[12:15], v[148:151], v[136:139]
    ds_read_b128 v[144:147], v182 offset:1600
    v_mfma_f32_16x16x32_bf16 v[140:143], a[44:47], v[148:151], v[140:143]
    s_waitcnt lgkmcnt(3)
    v_mfma_f32_16x16x32_bf16 v[136:139], a[16:19], v[152:155], v[136:139]
    ds_read_b128 v[148:151], v182 offset:1536
    v_mfma_f32_16x16x32_bf16 v[140:143], a[48:51], v[152:155], v[140:143]
    s_waitcnt lgkmcnt(3)
    v_mfma_f32_16x16x32_bf16 v[136:139], a[20:23], v[156:159], v[136:139]
    ds_read_b128 v[152:155], v182 offset:1472
    v_mfma_f32_16x16x32_bf16 v[140:143], a[52:55], v[156:159], v[140:143]
    s_waitcnt lgkmcnt(3)
    v_mfma_f32_16x16x32_bf16 v[136:139], a[24:27], v[160:163], v[136:139]
    ds_read_b128 v[156:159], v182 offset:1408
    v_mfma_f32_16x16x32_bf16 v[140:143], a[56:59], v[160:163], v[140:143]
    s_waitcnt lgkmcnt(3)
    v_mfma_f32_16x16x32_bf16 v[136:139], a[28:31], v[144:147], v[136:139]
    ds_read_b128 v[160:163], v182 offset:1344
    v_mfma_f32_16x16x32_bf16 v[140:143], a[60:63], v[144:147], v[140:143]
    s_waitcnt lgkmcnt(3)
    v_mfma_f32_16x16x32_bf16 v[132:135], a[0:3], v[148:151], 0
    ds_read_b128 v[144:147], v182 offset:1280
    v_mfma_f32_16x16x32_bf16 v[136:139], a[32:35], v[148:151], v[136:139]
    v_mfma_f32_16x16x32_bf16 v[140:143], v[40:43], v[148:151], v[140:143]
    s_waitcnt lgkmcnt(3)
    v_mfma_f32_16x16x32_bf16 v[132:135], a[4:7], v[152:155], v[132:135]
    ds_read_b128 v[148:151], v182 offset:1216
    v_mfma_f32_16x16x32_bf16 v[136:139], a[36:39], v[152:155], v[136:139]
    v_mfma_f32_16x16x32_bf16 v[140:143], v[44:47], v[152:155], v[140:143]
    s_waitcnt lgkmcnt(3)
    v_mfma_f32_16x16x32_bf16 v[132:135], a[8:11], v[156:159], v[132:135]
    ds_read_b128 v[152:155], v182 offset:1152
    v_mfma_f32_16x16x32_bf16 v[136:139], a[40:43], v[156:159], v[136:139]
    v_mfma_f32_16x16x32_bf16 v[140:143], v[48:51], v[156:159], v[140:143]
    s_waitcnt lgkmcnt(3)
    v_mfma_f32_16x16x32_bf16 v[132:135], a[12:15], v[160:163], v[132:135]
    ds_read_b128 v[156:159], v182 offset:1088
    v_mfma_f32_16x16x32_bf16 v[136:139], a[44:47], v[160:163], v[136:139]
    v_mfma_f32_16x16x32_bf16 v[140:143], v[52:55], v[160:163], v[140:143]
    s_waitcnt lgkmcnt(3)
    v_mfma_f32_16x16x32_bf16 v[132:135], a[16:19], v[144:147], v[132:135]
    ds_read_b128 v[160:163], v182 offset:1024
    v_mfma_f32_16x16x32_bf16 v[136:139], a[48:51], v[144:147], v[136:139]
    v_mfma_f32_16x16x32_bf16 v[140:143], v[56:59], v[144:147], v[140:143]
    s_waitcnt lgkmcnt(3)
    v_mfma_f32_16x16x32_bf16 v[132:135], a[20:23], v[148:151], v[132:135]
    ds_read_b128 v[144:147], v182 offset:960
    v_mfma_f32_16x16x32_bf16 v[136:139], a[52:55], v[148:151], v[136:139]
    v_mfma_f32_16x16x32_bf16 v[140:143], v[60:63], v[148:151], v[140:143]
    s_waitcnt lgkmcnt(3)
    v_mfma_f32_16x16x32_bf16 v[132:135], a[24:27], v[152:155], v[132:135]
    ds_read_b128 v[148:151], v182 offset:896
    v_mfma_f32_16x16x32_bf16 v[136:139], a[56:59], v[152:155], v[136:139]
    v_mfma_f32_16x16x32_bf16 v[140:143], v[64:67], v[152:155], v[140:143]
    s_waitcnt lgkmcnt(3)
    v_mfma_f32_16x16x32_bf16 v[132:135], a[28:31], v[156:159], v[132:135]
    ds_read_b128 v[152:155], v182 offset:832
    v_mfma_f32_16x16x32_bf16 v[136:139], a[60:63], v[156:159], v[136:139]
    v_mfma_f32_16x16x32_bf16 v[140:143], v[68:71], v[156:159], v[140:143]
    s_waitcnt lgkmcnt(3)
    v_mfma_f32_16x16x32_bf16 v[128:131], a[0:3], v[160:163], 0
    ds_read_b128 v[156:159], v182 offset:768
    v_mfma_f32_16x16x32_bf16 v[132:135], a[32:35], v[160:163], v[132:135]
    v_mfma_f32_16x16x32_bf16 v[136:139], v[40:43], v[160:163], v[136:139]
    v_mfma_f32_16x16x32_bf16 v[140:143], v[72:75], v[160:163], v[140:143]
    s_waitcnt lgkmcnt(3)
    v_mfma_f32_16x16x32_bf16 v[128:131], a[4:7], v[144:147], v[128:131]
    ds_read_b128 v[160:163], v182 offset:704
    v_mfma_f32_16x16x32_bf16 v[132:135], a[36:39], v[144:147], v[132:135]
    v_mfma_f32_16x16x32_bf16 v[136:139], v[44:47], v[144:147], v[136:139]
    v_mfma_f32_16x16x32_bf16 v[140:143], v[76:79], v[144:147], v[140:143]
    s_waitcnt lgkmcnt(3)
    v_mfma_f32_16x16x32_bf16 v[128:131], a[8:11], v[148:151], v[128:131]
    ds_read_b128 v[144:147], v182 offset:640
    v_mfma_f32_16x16x32_bf16 v[132:135], a[40:43], v[148:151], v[132:135]
    v_mfma_f32_16x16x32_bf16 v[136:139], v[48:51], v[148:151], v[136:139]
    v_mfma_f32_16x16x32_bf16 v[140:143], v[80:83], v[148:151], v[140:143]
    s_waitcnt lgkmcnt(3)
    v_mfma_f32_16x16x32_bf16 v[128:131], a[12:15], v[152:155], v[128:131]
    ds_read_b128 v[148:151], v182 offset:576
    v_mfma_f32_16x16x32_bf16 v[132:135], a[44:47], v[152:155], v[132:135]
    v_mfma_f32_16x16x32_bf16 v[136:139], v[52:55], v[152:155], v[136:139]
    v_mfma_f32_16x16x32_bf16 v[140:143], v[84:87], v[152:155], v[140:143]
    s_waitcnt lgkmcnt(3)
    v_mfma_f32_16x16x32_bf16 v[128:131], a[16:19], v[156:159], v[128:131]
    ds_read_b128 v[152:155], v182 offset:512
    v_mfma_f32_16x16x32_bf16 v[132:135], a[48:51], v[156:159], v[132:135]
    v_mfma_f32_16x16x32_bf16 v[136:139], v[56:59], v[156:159], v[136:139]
    v_mfma_f32_16x16x32_bf16 v[140:143], v[88:91], v[156:159], v[140:143]
    s_waitcnt lgkmcnt(3)
    v_mfma_f32_16x16x32_bf16 v[128:131], a[20:23], v[160:163], v[128:131]
    ds_read_b128 v[156:159], v182 offset:448
    v_mfma_f32_16x16x32_bf16 v[132:135], a[52:55], v[160:163], v[132:135]
    v_mfma_f32_16x16x32_bf16 v[136:139], v[60:63], v[160:163], v[136:139]
    v_mfma_f32_16x16x32_bf16 v[140:143], v[92:95], v[160:163], v[140:143]
    s_waitcnt lgkmcnt(3)
    v_mfma_f32_16x16x32_bf16 v[128:131], a[24:27], v[144:147], v[128:131]
    ds_read_b128 v[160:163], v182 offset:384
    v_mfma_f32_16x16x32_bf16 v[132:135], a[56:59], v[144:147], v[132:135]
    v_mfma_f32_16x16x32_bf16 v[136:139], v[64:67], v[144:147], v[136:139]
    v_mfma_f32_16x16x32_bf16 v[140:143], v[96:99], v[144:147], v[140:143]
    s_waitcnt lgkmcnt(3)
    v_mfma_f32_16x16x32_bf16 v[128:131], a[28:31], v[148:151], v[128:131]
    ds_read_b128 v[144:147], v182 offset:320
    v_mfma_f32_16x16x32_bf16 v[132:135], a[60:63], v[148:151], v[132:135]
    v_mfma_f32_16x16x32_bf16 v[136:139], v[68:71], v[148:151], v[136:139]
    v_mfma_f32_16x16x32_bf16 v[140:143], v[100:103], v[148:151], v[140:143]
    s_waitcnt lgkmcnt(3)
    v_mfma_f32_16x16x32_bf16 v[124:127], a[0:3], v[152:155], 0
    ds_read_b128 v[148:151], v182 offset:256
    v_mfma_f32_16x16x32_bf16 v[128:131], a[32:35], v[152:155], v[128:131]
    v_mfma_f32_16x16x32_bf16 v[132:135], v[40:43], v[152:155], v[132:135]
    v_mfma_f32_16x16x32_bf16 v[136:139], v[72:75], v[152:155], v[136:139]
    v_mfma_f32_16x16x32_bf16 v[140:143], v[104:107], v[152:155], v[140:143]
    s_waitcnt lgkmcnt(3)
    v_mfma_f32_16x16x32_bf16 v[124:127], a[4:7], v[156:159], v[124:127]
    ds_read_b128 v[152:155], v182 offset:192
    v_mfma_f32_16x16x32_bf16 v[128:131], a[36:39], v[156:159], v[128:131]
    v_mfma_f32_16x16x32_bf16 v[132:135], v[44:47], v[156:159], v[132:135]
    v_mfma_f32_16x16x32_bf16 v[136:139], v[76:79], v[156:159], v[136:139]
    s_waitcnt lgkmcnt(3)
    v_mfma_f32_16x16x32_bf16 v[124:127], a[8:11], v[160:163], v[124:127]
    ds_read_b128 v[156:159], v182 offset:128
    v_mfma_f32_16x16x32_bf16 v[128:131], a[40:43], v[160:163], v[128:131]
    v_mfma_f32_16x16x32_bf16 v[132:135], v[48:51], v[160:163], v[132:135]
    v_mfma_f32_16x16x32_bf16 v[136:139], v[80:83], v[160:163], v[136:139]
    s_waitcnt lgkmcnt(3)
    v_mfma_f32_16x16x32_bf16 v[124:127], a[12:15], v[144:147], v[124:127]
    ds_read_b128 v[160:163], v182 offset:64
    v_mfma_f32_16x16x32_bf16 v[128:131], a[44:47], v[144:147], v[128:131]
    v_mfma_f32_16x16x32_bf16 v[132:135], v[52:55], v[144:147], v[132:135]
    v_mfma_f32_16x16x32_bf16 v[136:139], v[84:87], v[144:147], v[136:139]
    s_waitcnt lgkmcnt(3)
    v_mfma_f32_16x16x32_bf16 v[124:127], a[16:19], v[148:151], v[124:127]
    ds_read_b128 v[144:147], v182 offset:0
    v_mfma_f32_16x16x32_bf16 v[128:131], a[48:51], v[148:151], v[128:131]
    v_mfma_f32_16x16x32_bf16 v[132:135], v[56:59], v[148:151], v[132:135]
    v_mfma_f32_16x16x32_bf16 v[136:139], v[88:91], v[148:151], v[136:139]
    s_waitcnt lgkmcnt(3)
    v_mfma_f32_16x16x32_bf16 v[124:127], a[20:23], v[152:155], v[124:127]
    v_mfma_f32_16x16x32_bf16 v[128:131], a[52:55], v[152:155], v[128:131]
    v_mfma_f32_16x16x32_bf16 v[132:135], v[60:63], v[152:155], v[132:135]
    v_mfma_f32_16x16x32_bf16 v[136:139], v[92:95], v[152:155], v[136:139]
    s_waitcnt lgkmcnt(2)
    v_mfma_f32_16x16x32_bf16 v[124:127], a[24:27], v[156:159], v[124:127]
    v_mfma_f32_16x16x32_bf16 v[128:131], a[56:59], v[156:159], v[128:131]
    v_mfma_f32_16x16x32_bf16 v[132:135], v[64:67], v[156:159], v[132:135]
    v_mfma_f32_16x16x32_bf16 v[136:139], v[96:99], v[156:159], v[136:139]
    s_waitcnt lgkmcnt(1)
    v_mfma_f32_16x16x32_bf16 v[124:127], a[28:31], v[160:163], v[124:127]
    v_mfma_f32_16x16x32_bf16 v[128:131], a[60:63], v[160:163], v[128:131]
    v_mfma_f32_16x16x32_bf16 v[132:135], v[68:71], v[160:163], v[132:135]
    v_mfma_f32_16x16x32_bf16 v[136:139], v[100:103], v[160:163], v[136:139]
    s_waitcnt lgkmcnt(0)
    v_mfma_f32_16x16x32_bf16 v[124:127], a[32:35], v[144:147], v[124:127]
    v_mfma_f32_16x16x32_bf16 v[128:131], v[40:43], v[144:147], v[128:131]
    v_mfma_f32_16x16x32_bf16 v[132:135], v[72:75], v[144:147], v[132:135]
    v_mfma_f32_16x16x32_bf16 v[136:139], v[104:107], v[144:147], v[136:139]
    v_mfma_f32_16x16x32_bf16 v[140:143], v[30:33], v[108:111], v[140:143]
    s_nop 3
    v_cvt_pk_bf16_f32 v124, v124, v125
    v_cvt_pk_bf16_f32 v125, v126, v127
    v_cvt_pk_bf16_f32 v126, v128, v129
    v_cvt_pk_bf16_f32 v127, v130, v131
    s_nop 0
    v_permlane16_swap_b32 v124, v126
    v_permlane16_swap_b32 v125, v127
    buffer_store_dwordx4 v[124:127], v186, s[48:51], s88 offen offset:0 sc1
    v_cvt_pk_bf16_f32 v132, v132, v133
    v_cvt_pk_bf16_f32 v133, v134, v135
    v_cvt_pk_bf16_f32 v134, v136, v137
    v_cvt_pk_bf16_f32 v135, v138, v139
    s_nop 0
    v_permlane16_swap_b32 v132, v134
    v_permlane16_swap_b32 v133, v135
    buffer_store_dwordx4 v[132:135], v186, s[48:51], s88 offen offset:1024 sc1
    v_cvt_pk_bf16_f32 v140, v140, v141
    v_cvt_pk_bf16_f32 v141, v142, v143
    buffer_store_dwordx2 v[140:141], v185, s[48:51], s88 offen offset:2048 sc1
    s_branch Lc_done
Lc_odd:
    ds_read_b128 v[124:127], v182 offset:496
    ds_read_b128 v[128:131], v182 offset:1008
    ds_read_b128 v[132:135], v182 offset:1520
    ds_read_b128 v[136:139], v182 offset:2032
    ds_read_b128 v[144:147], v182 offset:4096
    ds_read_b128 v[148:151], v182 offset:4032
    ds_read_b128 v[152:155], v182 offset:3968
    ds_read_b128 v[156:159], v182 offset:3904
    s_waitcnt lgkmcnt(4)
    v_mfma_f32_16x16x32_bf16 v[30:33], v[124:127], v[10:13], 0
    v_mfma_f32_16x16x32_bf16 v[34:37], v[124:127], v[14:17], 0
    v_mfma_f32_16x16x32_bf16 v[20:23], v[128:131], v[10:13], 0
    v_mfma_f32_16x16x32_bf16 v[24:27], v[128:131], v[14:17], 0
    v_mfma_f32_16x16x32_bf16 v[164:167], v[132:135], v[10:13], 0
    v_mfma_f32_16x16x32_bf16 v[168:171], v[132:135], v[14:17], 0
    v_mfma_f32_16x16x32_bf16 v[172:175], v[136:139], v[10:13], 0
    v_mfma_f32_16x16x32_bf16 v[176:179], v[136:139], v[14:17], 0
    s_waitcnt lgkmcnt(3)
    v_mfma_f32_16x16x32_bf16 v[132:135], a[0:3], v[144:147], 0
    ds_read_b128 v[160:163], v182 offset:3840
    s_waitcnt lgkmcnt(3)
    v_mfma_f32_16x16x32_bf16 v[132:135], a[4:7], v[148:151], v[132:135]
    ds_read_b128 v[144:147], v182 offset:3776
    s_waitcnt lgkmcnt(3)
    v_mfma_f32_16x16x32_bf16 v[132:135], a[8:11], v[152:155], v[132:135]
    ds_read_b128 v[148:151], v182 offset:3712
    s_waitcnt lgkmcnt(3)
    v_mfma_f32_16x16x32_bf16 v[132:135], a[12:15], v[156:159], v[132:135]
    ds_read_b128 v[152:155], v182 offset:3648
    s_waitcnt lgkmcnt(3)
    v_mfma_f32_16x16x32_bf16 v[132:135], a[16:19], v[160:163], v[132:135]
    ds_read_b128 v[156:159], v182 offset:3584
    s_waitcnt lgkmcnt(3)
    v_mfma_f32_16x16x32_bf16 v[132:135], a[20:23], v[144:147], v[132:135]
    ds_read_b128 v[160:163], v182 offset:3520
    s_waitcnt lgkmcnt(3)
    v_mfma_f32_16x16x32_bf16 v[132:135], a[24:27], v[148:151], v[132:135]
    ds_read_b128 v[144:147], v182 offset:3456
    s_waitcnt lgkmcnt(3)
    v_mfma_f32_16x16x32_bf16 v[132:135], a[28:31], v[152:155], v[132:135]
    ds_read_b128 v[148:151], v182 offset:3392
    s_waitcnt lgkmcnt(3)
    v_mfma_f32_16x16x32_bf16 v[128:131], a[0:3], v[156:159], 0
    ds_read_b128 v[152:155], v182 offset:3328
    v_mfma_f32_16x16x32_bf16 v[132:135], a[32:35], v[156:159], v[132:135]
    v_cvt_pk_bf16_f32 v30, v30, v31
    s_waitcnt lgkmcnt(3)
    v_mfma_f32_16x16x32_bf16 v[128:131], a[4:7], v[160:163], v[128:131]
    ds_read_b128 v[156:159], v182 offset:3264
    v_cvt_pk_bf16_f32 v31, v32, v33
    v_mfma_f32_16x16x32_bf16 v[132:135], a[36:39], v[160:163], v[132:135]
    v_cvt_pk_bf16_f32 v32, v34, v35
    s_waitcnt lgkmcnt(3)
    v_mfma_f32_16x16x32_bf16 v[128:131], a[8:11], v[144:147], v[128:131]
    ds_read_b128 v[160:163], v182 offset:3200
    v_cvt_pk_bf16_f32 v33, v36, v37
    v_mfma_f32_16x16x32_bf16 v[132:135], a[40:43], v[144:147], v[132:135]
    v_cvt_pk_bf16_f32 v20, v20, v21
    s_waitcnt lgkmcnt(3)
    v_mfma_f32_16x16x32_bf16 v[128:131], a[12:15], v[148:151], v[128:131]
    ds_read_b128 v[144:147], v182 offset:3136
    v_cvt_pk_bf16_f32 v21, v22, v23
    v_mfma_f32_16x16x32_bf16 v[132:135], a[44:47], v[148:151], v[132:135]
    v_cvt_pk_bf16_f32 v22, v24, v25
    s_waitcnt lgkmcnt(3)
    v_mfma_f32_16x16x32_bf16 v[128:131], a[16:19], v[152:155], v[128:131]
    ds_read_b128 v[148:151], v182 offset:3072
    v_cvt_pk_bf16_f32 v23, v26, v27
    v_mfma_f32_16x16x32_bf16 v[132:135], a[48:51], v[152:155], v[132:135]
    v_cvt_pk_bf16_f32 v164, v164, v165
    s_waitcnt lgkmcnt(3)
    v_mfma_f32_16x16x32_bf16 v[128:131], a[20:23], v[156:159], v[128:131]
    ds_read_b128 v[152:155], v182 offset:3008
    v_cvt_pk_bf16_f32 v165, v166, v167
    v_mfma_f32_16x16x32_bf16 v[132:135], a[52:55], v[156:159], v[132:135]
    v_cvt_pk_bf16_f32 v166, v168, v169
    s_waitcnt lgkmcnt(3)
    v_mfma_f32_16x16x32_bf16 v[128:131], a[24:27], v[160:163], v[128:131]
    ds_read_b128 v[156:159], v182 offset:2944
    v_cvt_pk_bf16_f32 v167, v170, v171
    v_mfma_f32_16x16x32_bf16 v[132:135], a[56:59], v[160:163], v[132:135]
    v_cvt_pk_bf16_f32 v172, v172, v173
    s_waitcnt lgkmcnt(3)
    v_mfma_f32_16x16x32_bf16 v[128:131], a[28:31], v[144:147], v[128:131]
    ds_read_b128 v[160:163], v182 offset:2880
    v_cvt_pk_bf16_f32 v173, v174, v175
    v_mfma_f32_16x16x32_bf16 v[132:135], a[60:63], v[144:147], v[132:135]
    v_cvt_pk_bf16_f32 v174, v176, v177
    s_waitcnt lgkmcnt(3)
    v_mfma_f32_16x16x32_bf16 v[124:127], a[0:3], v[148:151], 0
    ds_read_b128 v[144:147], v182 offset:2816
    v_cvt_pk_bf16_f32 v175, v178, v179
    v_mfma_f32_16x16x32_bf16 v[128:131], a[32:35], v[148:151], v[128:131]
    v_mfma_f32_16x16x32_bf16 v[132:135], v[40:43], v[148:151], v[132:135]
    s_waitcnt lgkmcnt(3)
    v_mfma_f32_16x16x32_bf16 v[124:127], a[4:7], v[152:155], v[124:127]
    ds_read_b128 v[148:151], v182 offset:2752
    v_mfma_f32_16x16x32_bf16 v[128:131], a[36:39], v[152:155], v[128:131]
    v_mfma_f32_16x16x32_bf16 v[132:135], v[44:47], v[152:155], v[132:135]
    s_waitcnt lgkmcnt(3)
    v_mfma_f32_16x16x32_bf16 v[124:127], a[8:11], v[156:159], v[124:127]
    ds_read_b128 v[152:155], v182 offset:2688
    v_mfma_f32_16x16x32_bf16 v[128:131], a[40:43], v[156:159], v[128:131]
    v_mfma_f32_16x16x32_bf16 v[132:135], v[48:51], v[156:159], v[132:135]
    s_waitcnt lgkmcnt(3)
    v_mfma_f32_16x16x32_bf16 v[124:127], a[12:15], v[160:163], v[124:127]
    ds_read_b128 v[156:159], v182 offset:2624
    v_mfma_f32_16x16x32_bf16 v[128:131], a[44:47], v[160:163], v[128:131]
    v_mfma_f32_16x16x32_bf16 v[132:135], v[52:55], v[160:163], v[132:135]
    s_waitcnt lgkmcnt(3)
    v_mfma_f32_16x16x32_bf16 v[124:127], a[16:19], v[144:147], v[124:127]
    ds_read_b128 v[160:163], v182 offset:2560
    v_mfma_f32_16x16x32_bf16 v[128:131], a[48:51], v[144:147], v[128:131]
    v_mfma_f32_16x16x32_bf16 v[132:135], v[56:59], v[144:147], v[132:135]
    s_waitcnt lgkmcnt(3)
    v_mfma_f32_16x16x32_bf16 v[124:127], a[20:23], v[148:151], v[124:127]
    ds_read_b128 v[144:147], v182 offset:2496
    v_mfma_f32_16x16x32_bf16 v[128:131], a[52:55], v[148:151], v[128:131]
    v_mfma_f32_16x16x32_bf16 v[132:135], v[60:63], v[148:151], v[132:135]
    s_waitcnt lgkmcnt(3)
    v_mfma_f32_16x16x32_bf16 v[124:127], a[24:27], v[152:155], v[124:127]
    ds_read_b128 v[148:151], v182 offset:2432
    v_mfma_f32_16x16x32_bf16 v[128:131], a[56:59], v[152:155], v[128:131]
    v_mfma_f32_16x16x32_bf16 v[132:135], v[64:67], v[152:155], v[132:135]
    s_waitcnt lgkmcnt(3)
    v_mfma_f32_16x16x32_bf16 v[124:127], a[28:31], v[156:159], v[124:127]
    ds_read_b128 v[152:155], v182 offset:2368
    v_mfma_f32_16x16x32_bf16 v[128:131], a[60:63], v[156:159], v[128:131]
    v_mfma_f32_16x16x32_bf16 v[132:135], v[68:71], v[156:159], v[132:135]
    s_waitcnt lgkmcnt(3)
    v_mfma_f32_16x16x32_bf16 v[124:127], a[32:35], v[160:163], v[124:127]
    ds_read_b128 v[156:159], v182 offset:2304
    v_mfma_f32_16x16x32_bf16 v[128:131], v[40:43], v[160:163], v[128:131]
    v_mfma_f32_16x16x32_bf16 v[132:135], v[72:75], v[160:163], v[132:135]
    s_waitcnt lgkmcnt(3)
    v_mfma_f32_16x16x32_bf16 v[124:127], a[36:39], v[144:147], v[124:127]
    ds_read_b128 v[160:163], v182 offset:2240
    v_mfma_f32_16x16x32_bf16 v[128:131], v[44:47], v[144:147], v[128:131]
    v_mfma_f32_16x16x32_bf16 v[132:135], v[76:79], v[144:147], v[132:135]
    s_waitcnt lgkmcnt(3)
    v_mfma_f32_16x16x32_bf16 v[124:127], a[40:43], v[148:151], v[124:127]
    ds_read_b128 v[144:147], v182 offset:2176
    v_mfma_f32_16x16x32_bf16 v[128:131], v[48:51], v[148:151], v[128:131]
    v_mfma_f32_16x16x32_bf16 v[132:135], v[80:83], v[148:151], v[132:135]
    s_waitcnt lgkmcnt(3)
    v_mfma_f32_16x16x32_bf16 v[124:127], a[44:47], v[152:155], v[124:127]
    ds_read_b128 v[148:151], v182 offset:2112
    v_mfma_f32_16x16x32_bf16 v[128:131], v[52:55], v[152:155], v[128:131]
    v_mfma_f32_16x16x32_bf16 v[132:135], v[84:87], v[152:155], v[132:135]
    s_waitcnt lgkmcnt(3)
    v_mfma_f32_16x16x32_bf16 v[124:127], a[48:51], v[156:159], v[124:127]
    ds_read_b128 v[152:155], v182 offset:2048
    v_mfma_f32_16x16x32_bf16 v[128:131], v[56:59], v[156:159], v[128:131]
    v_mfma_f32_16x16x32_bf16 v[132:135], v[88:91], v[156:159], v[132:135]
    s_waitcnt lgkmcnt(3)
    v_mfma_f32_16x16x32_bf16 v[124:127], a[52:55], v[160:163], v[124:127]
    ds_read_b128 v[156:159], v182 offset:1984
    v_mfma_f32_16x16x32_bf16 v[128:131], v[60:63], v[160:163], v[128:131]
    v_mfma_f32_16x16x32_bf16 v[132:135], v[92:95], v[160:163], v[132:135]
    s_waitcnt lgkmcnt(3)
    v_mfma_f32_16x16x32_bf16 v[124:127], a[56:59], v[144:147], v[124:127]
    ds_read_b128 v[160:163], v182 offset:1920
    v_mfma_f32_16x16x32_bf16 v[128:131], v[64:67], v[144:147], v[128:131]
    v_mfma_f32_16x16x32_bf16 v[132:135], v[96:99], v[144:147], v[132:135]
    s_waitcnt lgkmcnt(3)
    v_mfma_f32_16x16x32_bf16 v[124:127], a[60:63], v[148:151], v[124:127]
    ds_read_b128 v[144:147], v182 offset:1856
    v_mfma_f32_16x16x32_bf16 v[128:131], v[68:71], v[148:151], v[128:131]
    v_mfma_f32_16x16x32_bf16 v[132:135], v[100:103], v[148:151], v[132:135]
    s_waitcnt lgkmcnt(3)
    v_mfma_f32_16x16x32_bf16 v[124:127], v[40:43], v[152:155], v[124:127]
    ds_read_b128 v[148:151], v182 offset:1792
    v_mfma_f32_16x16x32_bf16 v[128:131], v[72:75], v[152:155], v[128:131]
    v_mfma_f32_16x16x32_bf16 v[132:135], v[104:107], v[152:155], v[132:135]
    s_waitcnt lgkmcnt(3)
    v_mfma_f32_16x16x32_bf16 v[124:127], v[44:47], v[156:159], v[124:127]
    ds_read_b128 v[152:155], v182 offset:1728
    v_mfma_f32_16x16x32_bf16 v[128:131], v[76:79], v[156:159], v[128:131]
    s_waitcnt lgkmcnt(3)
    v_mfma_f32_16x16x32_bf16 v[124:127], v[48:51], v[160:163], v[124:127]
    ds_read_b128 v[156:159], v182 offset:1664
    v_mfma_f32_16x16x32_bf16 v[128:131], v[80:83], v[160:163], v[128:131]
    s_waitcnt lgkmcnt(3)
    v_mfma_f32_16x16x32_bf16 v[124:127], v[52:55], v[144:147], v[124:127]
    ds_read_b128 v[160:163], v182 offset:1600
    v_mfma_f32_16x16x32_bf16 v[128:131], v[84:87], v[144:147], v[128:131]
    s_waitcnt lgkmcnt(3)
    v_mfma_f32_16x16x32_bf16 v[124:127], v[56:59], v[148:151], v[124:127]
    ds_read_b128 v[144:147], v182 offset:1536
    v_mfma_f32_16x16x32_bf16 v[128:131], v[88:91], v[148:151], v[128:131]
    s_waitcnt lgkmcnt(3)
    v_mfma_f32_16x16x32_bf16 v[124:127], v[60:63], v[152:155], v[124:127]
    ds_read_b128 v[148:151], v182 offset:1472
    v_mfma_f32_16x16x32_bf16 v[128:131], v[92:95], v[152:155], v[128:131]
    s_waitcnt lgkmcnt(3)
    v_mfma_f32_16x16x32_bf16 v[124:127], v[64:67], v[156:159], v[124:127]
    ds_read_b128 v[152:155], v182 offset:1408
    v_mfma_f32_16x16x32_bf16 v[128:131], v[96:99], v[156:159], v[128:131]
    s_waitcnt lgkmcnt(3)
    v_mfma_f32_16x16x32_bf16 v[124:127], v[68:71], v[160:163], v[124:127]
    ds_read_b128 v[156:159], v182 offset:1344
    v_mfma_f32_16x16x32_bf16 v[128:131], v[100:103], v[160:163], v[128:131]
    s_waitcnt lgkmcnt(3)
    v_mfma_f32_16x16x32_bf16 v[124:127], v[72:75], v[144:147], v[124:127]
    ds_read_b128 v[160:163], v182 offset:1280
    v_mfma_f32_16x16x32_bf16 v[128:131], v[104:107], v[144:147], v[128:131]
    s_waitcnt lgkmcnt(3)
    v_mfma_f32_16x16x32_bf16 v[124:127], v[76:79], v[148:151], v[124:127]
    ds_read_b128 v[144:147], v182 offset:1216
    s_waitcnt lgkmcnt(3)
    v_mfma_f32_16x16x32_bf16 v[124:127], v[80:83], v[152:155], v[124:127]
    ds_read_b128 v[148:151], v182 offset:1152
    s_waitcnt lgkmcnt(3)
    v_mfma_f32_16x16x32_bf16 v[124:127], v[84:87], v[156:159], v[124:127]
    ds_read_b128 v[152:155], v182 offset:1088
    s_waitcnt lgkmcnt(3)
    v_mfma_f32_16x16x32_bf16 v[124:127], v[88:91], v[160:163], v[124:127]
    ds_read_b128 v[156:159], v182 offset:1024
    s_waitcnt lgkmcnt(3)
    v_mfma_f32_16x16x32_bf16 v[124:127], v[92:95], v[144:147], v[124:127]
    s_waitcnt lgkmcnt(2)
    v_mfma_f32_16x16x32_bf16 v[124:127], v[96:99], v[148:151], v[124:127]
    s_waitcnt lgkmcnt(1)
    v_mfma_f32_16x16x32_bf16 v[124:127], v[100:103], v[152:155], v[124:127]
    s_waitcnt lgkmcnt(0)
    v_mfma_f32_16x16x32_bf16 v[124:127], v[104:107], v[156:159], v[124:127]
    v_mfma_f32_16x16x32_bf16 v[132:135], v[30:33], v[120:123], v[132:135]
    v_mfma_f32_16x16x32_bf16 v[132:135], v[20:23], v[116:119], v[132:135]
    v_mfma_f32_16x16x32_bf16 v[132:135], v[164:167], v[112:115], v[132:135]
    v_mfma_f32_16x16x32_bf16 v[132:135], v[172:175], v[108:111], v[132:135]
    v_mfma_f32_16x16x32_bf16 v[128:131], v[30:33], v[116:119], v[128:131]
    v_mfma_f32_16x16x32_bf16 v[128:131], v[20:23], v[112:115], v[128:131]
    v_mfma_f32_16x16x32_bf16 v[128:131], v[164:167], v[108:111], v[128:131]
    v_mfma_f32_16x16x32_bf16 v[124:127], v[30:33], v[112:115], v[124:127]
    v_mfma_f32_16x16x32_bf16 v[124:127], v[20:23], v[108:111], v[124:127]
    s_nop 7
    v_cvt_pk_bf16_f32 v124, v124, v125
    v_cvt_pk_bf16_f32 v125, v126, v127
    v_cvt_pk_bf16_f32 v126, v128, v129
    v_cvt_pk_bf16_f32 v127, v130, v131
    s_nop 0
    v_permlane16_swap_b32 v124, v126
    v_permlane16_swap_b32 v125, v127
    buffer_store_dwordx4 v[124:127], v186, s[48:51], s88 offen offset:2560 sc1
    v_cvt_pk_bf16_f32 v132, v132, v133
    v_cvt_pk_bf16_f32 v133, v134, v135
    buffer_store_dwordx2 v[132:133], v185, s[48:51], s88 offen offset:3584 sc1
Lc_done:
    s_waitcnt vmcnt(0)
    v_mov_b32 v144, 162760
    s_mov_b64 exec, 1
    ds_add_rtn_u32 v145, v144, v9
    s_waitcnt lgkmcnt(0)
    v_readfirstlane_b32 s90, v145
    s_nop 0
    s_cmp_eq_u32 s90, 3
    s_cselect_b32 s90, s68, 268435456
    s_nop 1
    buffer_store_dword v18, off, s[48:51], s90 sc1
    s_mov_b64 exec, -1
    s_endpgm
Lgemm:
    v_lshlrev_b32 v2, 4, v1
    s_lshl_b32 s66, s61, 17
    s_lshl_b32 s90, s62, 13
    s_lshl_b32 s91, s60, 11
    s_add_u32 s90, s90, s91
    s_add_u32 s77, s90, s66
    s_lshl_b32 s90, s60, 15
    s_add_u32 s66, s66, s90
    s_memrealtime s[98:99]
    s_or_b32 s90, s2, s60
    s_cmp_eq_u32 s90, 0
    s_cselect_b32 s69, 0, 4096
    v_lshlrev_b32 v65, 7, v1
    v_mov_b32 v68, 0
    v_mov_b32 v69, 0
    v_mov_b32 v70, 0
    v_mov_b32 v71, 0
    s_mov_b32 s58, 256
    s_mov_b32 s59, 0x20000
    s_mov_b32 s46, 1409024
    s_mov_b32 s47, 0x20000
    s_lshl_b32 s90, s2, 2
    s_add_u32 s90, s90, s60
    s_mul_i32 s92, s90, 1408
    s_mul_i32 s93, s90, 2048
    s_waitcnt lgkmcnt(0)
    s_mov_b64 s[48:49], s[32:33]
    s_mov_b64 s[36:37], s[4:5]
    s_mov_b64 s[56:57], s[30:31]
    s_or_b32 s98, s98, 1
    v_mov_b32 v147, s98
    s_mov_b64 exec, 1
    buffer_store_dword v147, off, s[56:59], s69 sc1
    s_mov_b64 exec, -1
    buffer_load_dwordx4 v[152:155], v2, s[36:39], s77 offen
    buffer_load_dwordx4 v[156:159], v2, s[36:39], s77 offen offset:1024
    s_mov_b64 s[44:45], s[24:25]
    s_mov_b32 s94, 0x3f803f80
    v_mov_b32 v3, 1
    v_lshlrev_b32 v64, 4, v0
    v_add_u32 v66, 157760, v64
    ds_write_b128 v66, v[68:71]
    v_min_u32 v66, 1040, v64
    v_add_u32 v66, 161856, v66
    ds_write_b128 v66, v[68:71]
    v_min_u32 v66, 544, v64
    v_add_u32 v66, 148480, v66
    ds_write_b128 v66, v[68:71]
    ds_write_b128 v66, v[68:71] offset:4640
    v_mov_b32 v66, 153104
    ds_write_b128 v66, v[68:71]
    ds_write_b128 v66, v[68:71] offset:4640
    v_and_b32 v67, 3, v1
    v_lshrrev_b32 v76, 4, v1
    v_lshrrev_b32 v78, 5, v1
    v_and_b32 v79, 31, v1
    v_bfe_u32 v66, v1, 1, 3
    s_lshl_b32 s90, s60, 1
    v_xor_b32 v66, v66, v78
    v_xor_b32 v66, s90, v66
    v_lshlrev_b32 v66, 4, v66
    v_lshl_add_u32 v66, v79, 7, v66
    v_add_u32 v4, s65, v66
    v_xor_b32 v5, 32, v4
    v_xor_b32 v6, 64, v4
    v_xor_b32 v7, 96, v4
    v_bfe_u32 v66, v1, 2, 2
    v_lshl_add_u32 v66, v78, 3, v66
    v_mul_u32_u24 v66, 192, v66
    v_and_b32 v72, 1, v76
    v_lshl_add_u32 v66, v72, 5, v66
    v_lshl_add_u32 v66, v67, 3, v66
    s_xor_b32 s90, s60, 0
    s_mul_i32 s90, s90, 3072
    s_add_u32 s90, s90, 65536
    v_add_u32 v8, s90, v66
    s_xor_b32 s90, s60, 1
    s_mul_i32 s90, s90, 3072
    s_add_u32 s90, s90, 65536
    v_add_u32 v9, s90, v66
    s_xor_b32 s90, s60, 2
    s_mul_i32 s90, s90, 3072
    s_add_u32 s90, s90, 65536
    v_add_u32 v10, s90, v66
    s_xor_b32 s90, s60, 3
    s_mul_i32 s90, s90, 3072
    s_add_u32 s90, s90, 65536
    v_add_u32 v11, s90, v66
    v_mov_b32 v13, 0
    v_mov_b32 v14, 0
    v_mov_b32 v15, 0
    s_mul_i32 s90, s62, 96
    v_add_u32 v73, s90, v79
    v_add_u32 v74, 0, v73
    v_min_u32 v74, 1375, v74
    v_lshlrev_b32 v148, 1, v74
    v_add_u32 v74, 32, v73
    v_min_u32 v74, 1375, v74
    v_lshlrev_b32 v149, 1, v74
    v_add_u32 v74, 64, v73
    v_min_u32 v74, 1375, v74
    v_lshlrev_b32 v150, 1, v74
    v_mov_b32 v160, 0
    s_lshr_b32 s90, s77, 7
    s_add_u32 s90, s90, 65536
    s_lshr_b32 s91, s77, 6
    s_add_u32 s91, s91, 81920
    v_lshl_add_u32 v161, v78, 4, s91
    v_cmp_eq_u32 vcc, 1, v72
    v_mov_b32 v162, s90
    s_lshr_b32 s90, s66, 6
    s_add_u32 s90, s90, 81920
    v_cndmask_b32 v161, v162, v161, vcc
    v_lshl_add_u32 v162, v79, 4, s90
    s_lshl_b32 s90, s60, 2
    s_add_u32 s90, s90, 162912
    v_mov_b32 v167, s90
    v_mov_b32 v168, 0
    v_mov_b32 v169, 0
    v_mov_b32 v170, 0
    v_mov_b32 v171, 0
    s_mov_b64 s[84:85], vcc
    buffer_load_dword v147, v160, s[56:59], 0 offen sc1
    s_waitcnt vmcnt(1)
    v_dot2c_f32_bf16 v168, s94, v152
    v_dot2c_f32_bf16 v169, s94, v156
    v_dot2c_f32_bf16 v170, v152, v152
    v_dot2c_f32_bf16 v171, v156, v156
    v_dot2c_f32_bf16 v168, s94, v153
    v_dot2c_f32_bf16 v169, s94, v157
    v_dot2c_f32_bf16 v170, v153, v153
    v_dot2c_f32_bf16 v171, v157, v157
    v_dot2c_f32_bf16 v168, s94, v154
    v_dot2c_f32_bf16 v169, s94, v158
    v_dot2c_f32_bf16 v170, v154, v154
    v_dot2c_f32_bf16 v171, v158, v158
    v_dot2c_f32_bf16 v168, s94, v155
    v_dot2c_f32_bf16 v169, s94, v159
    v_dot2c_f32_bf16 v170, v155, v155
    v_dot2c_f32_bf16 v171, v159, v159
    s_nop 0
    v_permlane32_swap_b32 v168, v169
    s_nop 0
    v_permlane32_swap_b32 v170, v171
    v_add_f32 v168, v168, v169
    v_add_f32 v170, v170, v171
    s_nop 1
    v_permlane16_swap_b32 v168, v170
    v_add_f32 v168, v168, v170
    s_nop 1
    v_add_f32_dpp v168, v168, v168 row_ror:8 row_mask:0xf bank_mask:0xf
    s_nop 1
    v_add_f32_dpp v168, v168, v168 row_ror:4 row_mask:0xf bank_mask:0xf
    s_nop 1
    v_add_f32_dpp v168, v168, v168 row_ror:2 row_mask:0xf bank_mask:0xf
    s_nop 1
    v_add_f32_dpp v168, v168, v168 row_ror:1 row_mask:0xf bank_mask:0xf
    v_mov_b32 v169, v168
    s_nop 1
    v_permlane16_swap_b32 v168, v169
    v_mul_f32 v168, 0x3b000000, v168
    v_mul_f32 v169, 0x3b000000, v169
    v_fma_f32 v169, -v168, v168, v169
    v_max_f32 v169, 0, v169
    v_cvt_pk_bf16_f32 v170, 0, v168
    v_cvt_pk_bf16_f32 v172, 0, v169
    v_add_f32 v172, 0x3727c5ac, v172
    v_cvt_pk_bf16_f32 v172, 0, v172
    v_sqrt_f32 v172, v172
    v_sub_f32 v168, v168, v170
    v_cvt_pk_bf16_f32 v172, 0, v172
    v_rcp_f32 v171, v172
    s_nop 0
    v_mul_f32 v169, v169, v171
    v_mul_f32 v168, v168, v171
    v_mul_f32 v169, v169, v171
    v_cvt_pk_bf16_f32 v168, 0, v168
    v_cvt_pk_bf16_f32 v169, 0, v169
    v_fma_f32 v168, -v168, v172, -v170
    v_add_f32 v169, 0x3727c5ac, v169
    v_cvt_pk_bf16_f32 v169, 0, v169
    v_sqrt_f32 v169, v169
    v_mov_b32 v173, v170
    v_cvt_pk_bf16_f32 v169, 0, v169
    v_mov_b32 v174, v171
    v_mul_f32 v169, v169, v172
    v_permlane32_swap_b32 v170, v173
    v_permlane32_swap_b32 v171, v174
    v_cvt_pk_bf16_f32 v170, v170, v173
    s_waitcnt vmcnt(0)
    v_cmp_eq_u32 vcc, 0, v147
    s_mov_b32 s87, 0
    s_cmp_eq_u64 vcc, 0
    s_cbranch_scc1 Lok_11
Lspin_12:
    buffer_load_dword v147, v160, s[56:59], 0 offen sc1
    s_add_u32 s87, s87, 1
    s_waitcnt vmcnt(0)
    v_cmp_eq_u32 vcc, 0, v147
    s_cmp_gt_u32 s87, 262144
    s_cbranch_scc1 Lok_11
    s_cmp_eq_u64 vcc, 0
    s_cbranch_scc0 Lspin_12
Lok_11:
    v_cndmask_b32 v168, v170, v168, s[84:85]
    v_cndmask_b32 v169, v171, v169, s[84:85]
    v_cndmask_b32 v170, v174, v147, s[84:85]
    v_mov_b32 v171, v147
    ds_write_b32 v167, v147
    s_mov_b32 exec_lo, 0x10001
    s_mov_b32 exec_hi, 0x10000
    buffer_store_dwordx4 v[168:171], v161, s[48:51], 0 offen sc1
    s_mov_b64 exec, -1
    global_load_short_d16_hi v144, v148, s[22:23]
    global_load_short_d16_hi v145, v149, s[22:23]
    global_load_short_d16_hi v146, v150, s[22:23]
    v_lshlrev_b32 v166, 7, v1
    s_mov_b64 exec, 0x7ff
    buffer_load_dword v190, v166, s[44:47], s92 offen
    s_mov_b64 exec, -1
    s_waitcnt lgkmcnt(0)
    s_barrier
    ds_read_b128 v[64:67], v4 offset:0
    ds_read_b64_tr_b16 v[96:97], v8 offset:0
    ds_read_b64_tr_b16 v[98:99], v8 offset:768
    ds_read_b64_tr_b16 v[100:101], v8 offset:64
    ds_read_b64_tr_b16 v[102:103], v8 offset:832
    ds_read_b64_tr_b16 v[104:105], v8 offset:128
    ds_read_b64_tr_b16 v[106:107], v8 offset:896
    ds_read_b128 v[68:71], v5 offset:0
    ds_read_b64_tr_b16 v[120:121], v9 offset:0
    ds_read_b64_tr_b16 v[122:123], v9 offset:768
    ds_read_b64_tr_b16 v[124:125], v9 offset:64
    ds_read_b64_tr_b16 v[126:127], v9 offset:832
    ds_read_b64_tr_b16 v[128:129], v9 offset:128
    ds_read_b64_tr_b16 v[130:131], v9 offset:896
    s_waitcnt lgkmcnt(7)
    v_mfma_f32_32x32x16_bf16 v[16:31], v[96:99], v[64:67], 0
    ds_read_b128 v[72:75], v6 offset:0
    ds_read_b64_tr_b16 v[132:133], v10 offset:0
    ds_read_b64_tr_b16 v[134:135], v10 offset:768
    v_mfma_f32_32x32x16_bf16 v[32:47], v[100:103], v[64:67], 0
    ds_read_b64_tr_b16 v[136:137], v10 offset:64
    ds_read_b64_tr_b16 v[138:139], v10 offset:832
    v_mfma_f32_32x32x16_bf16 v[48:63], v[104:107], v[64:67], 0
    ds_read_b64_tr_b16 v[140:141], v10 offset:128
    ds_read_b64_tr_b16 v[142:143], v10 offset:896
    s_waitcnt lgkmcnt(7)
    v_mfma_f32_32x32x16_bf16 v[16:31], v[120:123], v[68:71], v[16:31]
    ds_read_b128 v[76:79], v7 offset:0
    ds_read_b64_tr_b16 v[120:121], v11 offset:0
    ds_read_b64_tr_b16 v[122:123], v11 offset:768
    v_mfma_f32_32x32x16_bf16 v[32:47], v[124:127], v[68:71], v[32:47]
    ds_read_b64_tr_b16 v[124:125], v11 offset:64
    ds_read_b64_tr_b16 v[126:127], v11 offset:832
    v_mfma_f32_32x32x16_bf16 v[48:63], v[128:131], v[68:71], v[48:63]
    ds_read_b64_tr_b16 v[128:129], v11 offset:128
    ds_read_b64_tr_b16 v[130:131], v11 offset:896
    s_waitcnt lgkmcnt(7)
    v_mfma_f32_32x32x16_bf16 v[16:31], v[132:135], v[72:75], v[16:31]
    s_mov_b32 s84, 0xbdd2d3e8
    s_mov_b32 s85, 0xc0135761
    s_lshl_b32 s90, s61, 2
    s_add_u32 s90, s90, s60
    s_mul_i32 s91, s90, 86
    v_mfma_f32_32x32x16_bf16 v[32:47], v[136:139], v[72:75], v[32:47]
    s_mul_i32 s92, s62, 6
    s_add_u32 s92, s92, s91
    s_lshl_b32 s92, s92, 10
    s_add_u32 s88, s92, 4718592
    s_add_u32 s89, s88, 2048
    v_mfma_f32_32x32x16_bf16 v[48:63], v[140:143], v[72:75], v[48:63]
    s_cmp_ge_u32 s62, 14
    s_cselect_b32 s89, 268435456, s89
    s_cmp_ge_u32 s62, 15
    s_cselect_b32 s88, 268435456, s88
    s_lshl_b32 s68, s90, 4
    s_add_u32 s68, s68, s62
    s_lshl_b32 s68, s68, 7
    s_add_u32 s68, s68, 131072
    s_waitcnt lgkmcnt(0)
    s_barrier
    v_mfma_f32_32x32x16_bf16 v[16:31], v[120:123], v[76:79], v[16:31]
    ds_read_b128 v[80:83], v4 offset:16384
    ds_read_b64_tr_b16 v[108:109], v8 offset:12288
    ds_read_b64_tr_b16 v[110:111], v8 offset:13056
    ds_read_b64_tr_b16 v[112:113], v8 offset:12352
    ds_read_b64_tr_b16 v[114:115], v8 offset:13120
    v_mfma_f32_32x32x16_bf16 v[32:47], v[124:127], v[76:79], v[32:47]
    ds_read_b64_tr_b16 v[116:117], v8 offset:12416
    ds_read_b64_tr_b16 v[118:119], v8 offset:13184
    ds_read_b128 v[84:87], v5 offset:16384
    ds_read_b64_tr_b16 v[132:133], v9 offset:12288
    ds_read_b64_tr_b16 v[134:135], v9 offset:13056
    v_mfma_f32_32x32x16_bf16 v[48:63], v[128:131], v[76:79], v[48:63]
    ds_read_b64_tr_b16 v[136:137], v9 offset:12352
    ds_read_b64_tr_b16 v[138:139], v9 offset:13120
    ds_read_b64_tr_b16 v[140:141], v9 offset:12416
    ds_read_b64_tr_b16 v[142:143], v9 offset:13184
    v_dot2c_f32_bf16 v13, s94, v96
    v_dot2c_f32_bf16 v14, s94, v100
    v_dot2c_f32_bf16 v15, s94, v104
    v_dot2c_f32_bf16 v13, s94, v97
    v_dot2c_f32_bf16 v14, s94, v101
    v_dot2c_f32_bf16 v15, s94, v105
    v_dot2c_f32_bf16 v13, s94, v98
    v_dot2c_f32_bf16 v14, s94, v102
    v_dot2c_f32_bf16 v15, s94, v106
    v_dot2c_f32_bf16 v13, s94, v99
    v_dot2c_f32_bf16 v14, s94, v103
    v_dot2c_f32_bf16 v15, s94, v107
    s_waitcnt lgkmcnt(7)
    v_mfma_f32_32x32x16_bf16 v[16:31], v[108:111], v[80:83], v[16:31]
    ds_read_b128 v[88:91], v6 offset:16384
    ds_read_b64_tr_b16 v[120:121], v10 offset:12288
    ds_read_b64_tr_b16 v[122:123], v10 offset:13056
    v_mfma_f32_32x32x16_bf16 v[32:47], v[112:115], v[80:83], v[32:47]
    ds_read_b64_tr_b16 v[124:125], v10 offset:12352
    ds_read_b64_tr_b16 v[126:127], v10 offset:13120
    v_mfma_f32_32x32x16_bf16 v[48:63], v[116:119], v[80:83], v[48:63]
    ds_read_b64_tr_b16 v[128:129], v10 offset:12416
    ds_read_b64_tr_b16 v[130:131], v10 offset:13184
    s_waitcnt lgkmcnt(7)
    v_mfma_f32_32x32x16_bf16 v[16:31], v[132:135], v[84:87], v[16:31]
    ds_read_b128 v[92:95], v7 offset:16384
    ds_read_b64_tr_b16 v[132:133], v11 offset:12288
    ds_read_b64_tr_b16 v[134:135], v11 offset:13056
    v_mfma_f32_32x32x16_bf16 v[32:47], v[136:139], v[84:87], v[32:47]
    ds_read_b64_tr_b16 v[136:137], v11 offset:12352
    ds_read_b64_tr_b16 v[138:139], v11 offset:13120
    v_mfma_f32_32x32x16_bf16 v[48:63], v[140:143], v[84:87], v[48:63]
    ds_read_b64_tr_b16 v[140:141], v11 offset:12416
    ds_read_b64_tr_b16 v[142:143], v11 offset:13184
    s_waitcnt lgkmcnt(7)
    v_mfma_f32_32x32x16_bf16 v[16:31], v[120:123], v[88:91], v[16:31]
    s_lshl_b32 s90, s60, 2
    s_add_u32 s90, s90, 145408
    v_add_u32 v189, s90, v2
    v_and_b32 v188, 31, v1
    v_lshlrev_b32 v188, 4, v188
    v_mfma_f32_32x32x16_bf16 v[32:47], v[124:127], v[88:91], v[32:47]
    v_add_u32 v188, 145408, v188
    v_mfma_f32_32x32x16_bf16 v[48:63], v[128:131], v[88:91], v[48:63]
    s_waitcnt lgkmcnt(0)
    s_barrier
    v_mfma_f32_32x32x16_bf16 v[16:31], v[132:135], v[92:95], v[16:31]
    ds_read_b128 v[64:67], v4 offset:32768
    ds_read_b64_tr_b16 v[96:97], v8 offset:24576
    ds_read_b64_tr_b16 v[98:99], v8 offset:25344
    ds_read_b64_tr_b16 v[100:101], v8 offset:24640
    ds_read_b64_tr_b16 v[102:103], v8 offset:25408
    v_mfma_f32_32x32x16_bf16 v[32:47], v[136:139], v[92:95], v[32:47]
    ds_read_b64_tr_b16 v[104:105], v8 offset:24704
    ds_read_b64_tr_b16 v[106:107], v8 offset:25472
    ds_read_b128 v[68:71], v5 offset:32768
    ds_read_b64_tr_b16 v[120:121], v9 offset:24576
    ds_read_b64_tr_b16 v[122:123], v9 offset:25344
    v_mfma_f32_32x32x16_bf16 v[48:63], v[140:143], v[92:95], v[48:63]
    ds_read_b64_tr_b16 v[124:125], v9 offset:24640
    ds_read_b64_tr_b16 v[126:127], v9 offset:25408
    ds_read_b64_tr_b16 v[128:129], v9 offset:24704
    ds_read_b64_tr_b16 v[130:131], v9 offset:25472
    v_dot2c_f32_bf16 v13, s94, v108
    v_dot2c_f32_bf16 v14, s94, v112
    v_dot2c_f32_bf16 v15, s94, v116
    v_dot2c_f32_bf16 v13, s94, v109
    v_dot2c_f32_bf16 v14, s94, v113
    v_dot2c_f32_bf16 v15, s94, v117
    v_dot2c_f32_bf16 v13, s94, v110
    v_dot2c_f32_bf16 v14, s94, v114
    v_dot2c_f32_bf16 v15, s94, v118
    v_dot2c_f32_bf16 v13, s94, v111
    v_dot2c_f32_bf16 v14, s94, v115
    v_dot2c_f32_bf16 v15, s94, v119
    s_waitcnt lgkmcnt(7)
    v_mfma_f32_32x32x16_bf16 v[16:31], v[96:99], v[64:67], v[16:31]
    ds_read_b128 v[72:75], v6 offset:32768
    ds_read_b64_tr_b16 v[132:133], v10 offset:24576
    ds_read_b64_tr_b16 v[134:135], v10 offset:25344
    v_mfma_f32_32x32x16_bf16 v[32:47], v[100:103], v[64:67], v[32:47]
    ds_read_b64_tr_b16 v[136:137], v10 offset:24640
    ds_read_b64_tr_b16 v[138:139], v10 offset:25408
    v_mfma_f32_32x32x16_bf16 v[48:63], v[104:107], v[64:67], v[48:63]
    ds_read_b64_tr_b16 v[140:141], v10 offset:24704
    ds_read_b64_tr_b16 v[142:143], v10 offset:25472
    s_waitcnt lgkmcnt(7)
    v_mfma_f32_32x32x16_bf16 v[16:31], v[120:123], v[68:71], v[16:31]
    ds_read_b128 v[76:79], v7 offset:32768
    ds_read_b64_tr_b16 v[120:121], v11 offset:24576
    ds_read_b64_tr_b16 v[122:123], v11 offset:25344
    v_mfma_f32_32x32x16_bf16 v[32:47], v[124:127], v[68:71], v[32:47]
    ds_read_b64_tr_b16 v[124:125], v11 offset:24640
    ds_read_b64_tr_b16 v[126:127], v11 offset:25408
    v_mfma_f32_32x32x16_bf16 v[48:63], v[128:131], v[68:71], v[48:63]
    ds_read_b64_tr_b16 v[128:129], v11 offset:24704
    ds_read_b64_tr_b16 v[130:131], v11 offset:25472
    s_waitcnt lgkmcnt(7)
    v_mfma_f32_32x32x16_bf16 v[16:31], v[132:135], v[72:75], v[16:31]
    v_mfma_f32_32x32x16_bf16 v[32:47], v[136:139], v[72:75], v[32:47]
    v_mfma_f32_32x32x16_bf16 v[48:63], v[140:143], v[72:75], v[48:63]
    s_waitcnt lgkmcnt(0)
    s_barrier
    v_mfma_f32_32x32x16_bf16 v[16:31], v[120:123], v[76:79], v[16:31]
    ds_read_b128 v[80:83], v4 offset:49152
    ds_read_b64_tr_b16 v[108:109], v8 offset:36864
    ds_read_b64_tr_b16 v[110:111], v8 offset:37632
    ds_read_b64_tr_b16 v[112:113], v8 offset:36928
    ds_read_b64_tr_b16 v[114:115], v8 offset:37696
    v_mfma_f32_32x32x16_bf16 v[32:47], v[124:127], v[76:79], v[32:47]
    ds_read_b64_tr_b16 v[116:117], v8 offset:36992
    ds_read_b64_tr_b16 v[118:119], v8 offset:37760
    ds_read_b128 v[84:87], v5 offset:49152
    ds_read_b64_tr_b16 v[132:133], v9 offset:36864
    ds_read_b64_tr_b16 v[134:135], v9 offset:37632
    v_mfma_f32_32x32x16_bf16 v[48:63], v[128:131], v[76:79], v[48:63]
    ds_read_b64_tr_b16 v[136:137], v9 offset:36928
    ds_read_b64_tr_b16 v[138:139], v9 offset:37696
    ds_read_b64_tr_b16 v[140:141], v9 offset:36992
    ds_read_b64_tr_b16 v[142:143], v9 offset:37760
    v_dot2c_f32_bf16 v13, s94, v96
    v_dot2c_f32_bf16 v14, s94, v100
    v_dot2c_f32_bf16 v15, s94, v104
    v_dot2c_f32_bf16 v13, s94, v97
    v_dot2c_f32_bf16 v14, s94, v101
    v_dot2c_f32_bf16 v15, s94, v105
    v_dot2c_f32_bf16 v13, s94, v98
    v_dot2c_f32_bf16 v14, s94, v102
    v_dot2c_f32_bf16 v15, s94, v106
    v_dot2c_f32_bf16 v13, s94, v99
    v_dot2c_f32_bf16 v14, s94, v103
    v_dot2c_f32_bf16 v15, s94, v107
    s_waitcnt lgkmcnt(7)
    v_mfma_f32_32x32x16_bf16 v[16:31], v[108:111], v[80:83], v[16:31]
    ds_read_b128 v[88:91], v6 offset:49152
    ds_read_b64_tr_b16 v[120:121], v10 offset:36864
    ds_read_b64_tr_b16 v[122:123], v10 offset:37632
    v_mfma_f32_32x32x16_bf16 v[32:47], v[112:115], v[80:83], v[32:47]
    ds_read_b64_tr_b16 v[124:125], v10 offset:36928
    ds_read_b64_tr_b16 v[126:127], v10 offset:37696
    v_mfma_f32_32x32x16_bf16 v[48:63], v[116:119], v[80:83], v[48:63]
    ds_read_b64_tr_b16 v[128:129], v10 offset:36992
    ds_read_b64_tr_b16 v[130:131], v10 offset:37760
    s_waitcnt lgkmcnt(7)
    v_mfma_f32_32x32x16_bf16 v[16:31], v[132:135], v[84:87], v[16:31]
    ds_read_b128 v[92:95], v7 offset:49152
    ds_read_b64_tr_b16 v[132:133], v11 offset:36864
    ds_read_b64_tr_b16 v[134:135], v11 offset:37632
    v_mfma_f32_32x32x16_bf16 v[32:47], v[136:139], v[84:87], v[32:47]
    ds_read_b64_tr_b16 v[136:137], v11 offset:36928
    ds_read_b64_tr_b16 v[138:139], v11 offset:37696
    v_mfma_f32_32x32x16_bf16 v[48:63], v[140:143], v[84:87], v[48:63]
    ds_read_b64_tr_b16 v[140:141], v11 offset:36992
    ds_read_b64_tr_b16 v[142:143], v11 offset:37760
    s_waitcnt lgkmcnt(7)
    v_mfma_f32_32x32x16_bf16 v[16:31], v[120:123], v[88:91], v[16:31]
    buffer_load_dwordx3 v[168:170], v162, s[48:51], 0 offen sc1
    v_mfma_f32_32x32x16_bf16 v[32:47], v[124:127], v[88:91], v[32:47]
    v_mfma_f32_32x32x16_bf16 v[48:63], v[128:131], v[88:91], v[48:63]
    s_waitcnt lgkmcnt(0)
    s_barrier
    v_mfma_f32_32x32x16_bf16 v[16:31], v[132:135], v[92:95], v[16:31]
    ds_read_b128 v[64:67], v4 offset:0
    ds_read_b64_tr_b16 v[96:97], v8 offset:0
    ds_read_b64_tr_b16 v[98:99], v8 offset:768
    ds_read_b64_tr_b16 v[100:101], v8 offset:64
    ds_read_b64_tr_b16 v[102:103], v8 offset:832
    v_mfma_f32_32x32x16_bf16 v[32:47], v[136:139], v[92:95], v[32:47]
    ds_read_b64_tr_b16 v[104:105], v8 offset:128
    ds_read_b64_tr_b16 v[106:107], v8 offset:896
    ds_read_b128 v[68:71], v5 offset:0
    ds_read_b64_tr_b16 v[120:121], v9 offset:0
    ds_read_b64_tr_b16 v[122:123], v9 offset:768
    v_mfma_f32_32x32x16_bf16 v[48:63], v[140:143], v[92:95], v[48:63]
    ds_read_b64_tr_b16 v[124:125], v9 offset:64
    ds_read_b64_tr_b16 v[126:127], v9 offset:832
    ds_read_b64_tr_b16 v[128:129], v9 offset:128
    ds_read_b64_tr_b16 v[130:131], v9 offset:896
    v_dot2c_f32_bf16 v13, s94, v108
    v_dot2c_f32_bf16 v14, s94, v112
    v_dot2c_f32_bf16 v15, s94, v116
    v_dot2c_f32_bf16 v13, s94, v109
    v_dot2c_f32_bf16 v14, s94, v113
    v_dot2c_f32_bf16 v15, s94, v117
    v_dot2c_f32_bf16 v13, s94, v110
    v_dot2c_f32_bf16 v14, s94, v114
    v_dot2c_f32_bf16 v15, s94, v118
    v_dot2c_f32_bf16 v13, s94, v111
    v_dot2c_f32_bf16 v14, s94, v115
    v_dot2c_f32_bf16 v15, s94, v119
    s_waitcnt lgkmcnt(7)
    v_mfma_f32_32x32x16_bf16 v[16:31], v[96:99], v[64:67], v[16:31]
    ds_read_b128 v[72:75], v6 offset:0
    ds_read_b64_tr_b16 v[132:133], v10 offset:0
    ds_read_b64_tr_b16 v[134:135], v10 offset:768
    v_mfma_f32_32x32x16_bf16 v[32:47], v[100:103], v[64:67], v[32:47]
    ds_read_b64_tr_b16 v[136:137], v10 offset:64
    ds_read_b64_tr_b16 v[138:139], v10 offset:832
    v_mfma_f32_32x32x16_bf16 v[48:63], v[104:107], v[64:67], v[48:63]
    ds_read_b64_tr_b16 v[140:141], v10 offset:128
    ds_read_b64_tr_b16 v[142:143], v10 offset:896
    s_waitcnt lgkmcnt(7)
    v_mfma_f32_32x32x16_bf16 v[16:31], v[120:123], v[68:71], v[16:31]
    ds_read_b128 v[76:79], v7 offset:0
    ds_read_b64_tr_b16 v[120:121], v11 offset:0
    ds_read_b64_tr_b16 v[122:123], v11 offset:768
    v_mfma_f32_32x32x16_bf16 v[32:47], v[124:127], v[68:71], v[32:47]
    ds_read_b64_tr_b16 v[124:125], v11 offset:64
    ds_read_b64_tr_b16 v[126:127], v11 offset:832
    v_mfma_f32_32x32x16_bf16 v[48:63], v[128:131], v[68:71], v[48:63]
    ds_read_b64_tr_b16 v[128:129], v11 offset:128
    ds_read_b64_tr_b16 v[130:131], v11 offset:896
    s_waitcnt lgkmcnt(7)
    v_mfma_f32_32x32x16_bf16 v[16:31], v[132:135], v[72:75], v[16:31]
    v_mfma_f32_32x32x16_bf16 v[32:47], v[136:139], v[72:75], v[32:47]
    v_mfma_f32_32x32x16_bf16 v[48:63], v[140:143], v[72:75], v[48:63]
    s_waitcnt lgkmcnt(0)
    s_barrier
    v_mfma_f32_32x32x16_bf16 v[16:31], v[120:123], v[76:79], v[16:31]
    ds_read_b128 v[80:83], v4 offset:16384
    ds_read_b64_tr_b16 v[108:109], v8 offset:12288
    ds_read_b64_tr_b16 v[110:111], v8 offset:13056
    ds_read_b64_tr_b16 v[112:113], v8 offset:12352
    ds_read_b64_tr_b16 v[114:115], v8 offset:13120
    v_mfma_f32_32x32x16_bf16 v[32:47], v[124:127], v[76:79], v[32:47]
    ds_read_b64_tr_b16 v[116:117], v8 offset:12416
    ds_read_b64_tr_b16 v[118:119], v8 offset:13184
    ds_read_b128 v[84:87], v5 offset:16384
    ds_read_b64_tr_b16 v[132:133], v9 offset:12288
    ds_read_b64_tr_b16 v[134:135], v9 offset:13056
    v_mfma_f32_32x32x16_bf16 v[48:63], v[128:131], v[76:79], v[48:63]
    ds_read_b64_tr_b16 v[136:137], v9 offset:12352
    ds_read_b64_tr_b16 v[138:139], v9 offset:13120
    ds_read_b64_tr_b16 v[140:141], v9 offset:12416
    ds_read_b64_tr_b16 v[142:143], v9 offset:13184
    v_dot2c_f32_bf16 v13, s94, v96
    v_dot2c_f32_bf16 v14, s94, v100
    v_dot2c_f32_bf16 v15, s94, v104
    v_dot2c_f32_bf16 v13, s94, v97
    v_dot2c_f32_bf16 v14, s94, v101
    v_dot2c_f32_bf16 v15, s94, v105
    v_dot2c_f32_bf16 v13, s94, v98
    v_dot2c_f32_bf16 v14, s94, v102
    v_dot2c_f32_bf16 v15, s94, v106
    v_dot2c_f32_bf16 v13, s94, v99
    v_dot2c_f32_bf16 v14, s94, v103
    v_dot2c_f32_bf16 v15, s94, v107
    s_waitcnt lgkmcnt(7)
    v_mfma_f32_32x32x16_bf16 v[16:31], v[108:111], v[80:83], v[16:31]
    ds_read_b128 v[88:91], v6 offset:16384
    ds_read_b64_tr_b16 v[120:121], v10 offset:12288
    ds_read_b64_tr_b16 v[122:123], v10 offset:13056
    v_mfma_f32_32x32x16_bf16 v[32:47], v[112:115], v[80:83], v[32:47]
    ds_read_b64_tr_b16 v[124:125], v10 offset:12352
    ds_read_b64_tr_b16 v[126:127], v10 offset:13120
    v_mfma_f32_32x32x16_bf16 v[48:63], v[116:119], v[80:83], v[48:63]
    ds_read_b64_tr_b16 v[128:129], v10 offset:12416
    ds_read_b64_tr_b16 v[130:131], v10 offset:13184
    s_waitcnt lgkmcnt(7)
    v_mfma_f32_32x32x16_bf16 v[16:31], v[132:135], v[84:87], v[16:31]
    ds_read_b128 v[92:95], v7 offset:16384
    ds_read_b64_tr_b16 v[132:133], v11 offset:12288
    ds_read_b64_tr_b16 v[134:135], v11 offset:13056
    v_mfma_f32_32x32x16_bf16 v[32:47], v[136:139], v[84:87], v[32:47]
    ds_read_b64_tr_b16 v[136:137], v11 offset:12352
    ds_read_b64_tr_b16 v[138:139], v11 offset:13120
    v_mfma_f32_32x32x16_bf16 v[48:63], v[140:143], v[84:87], v[48:63]
    ds_read_b64_tr_b16 v[140:141], v11 offset:12416
    ds_read_b64_tr_b16 v[142:143], v11 offset:13184
    s_waitcnt lgkmcnt(7)
    v_mfma_f32_32x32x16_bf16 v[16:31], v[120:123], v[88:91], v[16:31]
    s_waitcnt vmcnt(0)
    v_cmp_ne_u32 vcc, v170, v147
    s_mov_b32 s87, 0
    s_cmp_eq_u64 vcc, 0
    s_cbranch_scc1 Lok_13
Lspin_14:
    buffer_load_dwordx3 v[168:170], v162, s[48:51], 0 offen sc1
    s_add_u32 s87, s87, 1
    s_waitcnt vmcnt(0)
    v_cmp_ne_u32 vcc, v170, v147
    s_cmp_gt_u32 s87, 262144
    s_cbranch_scc1 Lok_13
    s_cmp_eq_u64 vcc, 0
    s_cbranch_scc0 Lspin_14
Lok_13:
    v_cvt_pk_bf16_f32 v148, v168, v168
    v_cvt_pk_bf16_f32 v171, 0, v169
    v_rcp_f32 v12, v169
    v_mfma_f32_32x32x16_bf16 v[32:47], v[124:127], v[88:91], v[32:47]
    v_and_b32 v170, 0xffff0000, v148
    v_sub_f32 v171, v169, v171
    v_sub_f32 v170, v168, v170
    v_cvt_pk_bf16_f32 v150, v171, 0
    v_cvt_pk_bf16_f32 v149, v170, v169
    v_mfma_f32_32x32x16_bf16 v[48:63], v[128:131], v[88:91], v[48:63]
    v_mov_b32 v151, 0
    s_mov_b32 exec_lo, 0
    v_mov_b32 v148, 0
    v_mov_b32 v149, 0
    v_mov_b32 v150, 0
    s_mov_b32 exec_lo, -1
    s_waitcnt lgkmcnt(0)
    s_barrier
    v_mfma_f32_32x32x16_bf16 v[16:31], v[132:135], v[92:95], v[16:31]
    ds_read_b128 v[64:67], v4 offset:32768
    ds_read_b64_tr_b16 v[96:97], v8 offset:24576
    ds_read_b64_tr_b16 v[98:99], v8 offset:25344
    ds_read_b64_tr_b16 v[100:101], v8 offset:24640
    ds_read_b64_tr_b16 v[102:103], v8 offset:25408
    v_mfma_f32_32x32x16_bf16 v[32:47], v[136:139], v[92:95], v[32:47]
    ds_read_b64_tr_b16 v[104:105], v8 offset:24704
    ds_read_b64_tr_b16 v[106:107], v8 offset:25472
    ds_read_b128 v[68:71], v5 offset:32768
    ds_read_b64_tr_b16 v[120:121], v9 offset:24576
    ds_read_b64_tr_b16 v[122:123], v9 offset:25344
    v_mfma_f32_32x32x16_bf16 v[48:63], v[140:143], v[92:95], v[48:63]
    ds_read_b64_tr_b16 v[124:125], v9 offset:24640
    ds_read_b64_tr_b16 v[126:127], v9 offset:25408
    ds_read_b64_tr_b16 v[128:129], v9 offset:24704
    ds_read_b64_tr_b16 v[130:131], v9 offset:25472
    v_dot2c_f32_bf16 v13, s94, v108
    v_dot2c_f32_bf16 v14, s94, v112
    v_dot2c_f32_bf16 v15, s94, v116
    v_dot2c_f32_bf16 v13, s94, v109
    v_dot2c_f32_bf16 v14, s94, v113
    v_dot2c_f32_bf16 v15, s94, v117
    v_dot2c_f32_bf16 v13, s94, v110
    v_dot2c_f32_bf16 v14, s94, v114
    v_dot2c_f32_bf16 v15, s94, v118
    v_dot2c_f32_bf16 v13, s94, v111
    v_dot2c_f32_bf16 v14, s94, v115
    v_dot2c_f32_bf16 v15, s94, v119
    s_waitcnt lgkmcnt(7)
    v_mfma_f32_32x32x16_bf16 v[16:31], v[96:99], v[64:67], v[16:31]
    ds_read_b128 v[72:75], v6 offset:32768
    ds_read_b64_tr_b16 v[132:133], v10 offset:24576
    ds_read_b64_tr_b16 v[134:135], v10 offset:25344
    v_mfma_f32_32x32x16_bf16 v[32:47], v[100:103], v[64:67], v[32:47]
    ds_read_b64_tr_b16 v[136:137], v10 offset:24640
    ds_read_b64_tr_b16 v[138:139], v10 offset:25408
    v_mfma_f32_32x32x16_bf16 v[48:63], v[104:107], v[64:67], v[48:63]
    ds_read_b64_tr_b16 v[140:141], v10 offset:24704
    ds_read_b64_tr_b16 v[142:143], v10 offset:25472
    s_waitcnt lgkmcnt(7)
    v_mfma_f32_32x32x16_bf16 v[16:31], v[120:123], v[68:71], v[16:31]
    ds_read_b128 v[76:79], v7 offset:32768
    ds_read_b64_tr_b16 v[120:121], v11 offset:24576
    ds_read_b64_tr_b16 v[122:123], v11 offset:25344
    v_mfma_f32_32x32x16_bf16 v[32:47], v[124:127], v[68:71], v[32:47]
    ds_read_b64_tr_b16 v[124:125], v11 offset:24640
    ds_read_b64_tr_b16 v[126:127], v11 offset:25408
    v_mfma_f32_32x32x16_bf16 v[48:63], v[128:131], v[68:71], v[48:63]
    ds_read_b64_tr_b16 v[128:129], v11 offset:24704
    ds_read_b64_tr_b16 v[130:131], v11 offset:25472
    s_waitcnt lgkmcnt(7)
    v_mfma_f32_32x32x16_bf16 v[16:31], v[132:135], v[72:75], v[16:31]
    v_dot2c_f32_bf16 v13, s94, v96
    v_dot2c_f32_bf16 v14, s94, v100
    v_dot2c_f32_bf16 v15, s94, v104
    v_dot2c_f32_bf16 v13, s94, v97
    v_dot2c_f32_bf16 v14, s94, v101
    v_mfma_f32_32x32x16_bf16 v[32:47], v[136:139], v[72:75], v[32:47]
    v_dot2c_f32_bf16 v15, s94, v105
    v_dot2c_f32_bf16 v13, s94, v98
    v_dot2c_f32_bf16 v14, s94, v102
    v_dot2c_f32_bf16 v15, s94, v106
    v_dot2c_f32_bf16 v13, s94, v99
    v_mfma_f32_32x32x16_bf16 v[48:63], v[140:143], v[72:75], v[48:63]
    v_dot2c_f32_bf16 v14, s94, v103
    v_dot2c_f32_bf16 v15, s94, v107
    s_nop 2
    v_mov_b32 v164, v15
    v_permlane32_swap_b32 v13, v14
    s_nop 0
    v_permlane32_swap_b32 v15, v164
    v_add_f32 v166, v13, v14
    v_add_f32 v167, v15, v164
    ds_write_b32 v189, v166
    ds_write_b32 v189, v167 offset:1024
    v_mov_b32 v13, 0
    v_mov_b32 v14, 0
    v_mov_b32 v15, 0
    s_waitcnt lgkmcnt(0)
    s_barrier
    v_mfma_f32_32x32x16_bf16 v[16:31], v[120:123], v[76:79], v[16:31]
    ds_read_b128 v[80:83], v4 offset:49152
    ds_read_b64_tr_b16 v[108:109], v8 offset:36864
    ds_read_b64_tr_b16 v[110:111], v8 offset:37632
    ds_read_b64_tr_b16 v[112:113], v8 offset:36928
    ds_read_b64_tr_b16 v[114:115], v8 offset:37696
    v_mfma_f32_32x32x16_bf16 v[32:47], v[124:127], v[76:79], v[32:47]
    ds_read_b64_tr_b16 v[116:117], v8 offset:36992
    ds_read_b64_tr_b16 v[118:119], v8 offset:37760
    ds_read_b128 v[84:87], v5 offset:49152
    ds_read_b64_tr_b16 v[132:133], v9 offset:36864
    ds_read_b64_tr_b16 v[134:135], v9 offset:37632
    v_mfma_f32_32x32x16_bf16 v[48:63], v[128:131], v[76:79], v[48:63]
    ds_read_b64_tr_b16 v[136:137], v9 offset:36928
    ds_read_b64_tr_b16 v[138:139], v9 offset:37696
    ds_read_b64_tr_b16 v[140:141], v9 offset:36992
    ds_read_b64_tr_b16 v[142:143], v9 offset:37760
    s_waitcnt lgkmcnt(7)
    v_mfma_f32_32x32x16_bf16 v[16:31], v[108:111], v[80:83], v[16:31]
    ds_read_b128 v[88:91], v6 offset:49152
    ds_read_b64_tr_b16 v[120:121], v10 offset:36864
    ds_read_b64_tr_b16 v[122:123], v10 offset:37632
    v_mfma_f32_32x32x16_bf16 v[32:47], v[112:115], v[80:83], v[32:47]
    ds_read_b64_tr_b16 v[124:125], v10 offset:36928
    ds_read_b64_tr_b16 v[126:127], v10 offset:37696
    v_mfma_f32_32x32x16_bf16 v[48:63], v[116:119], v[80:83], v[48:63]
    ds_read_b64_tr_b16 v[128:129], v10 offset:36992
    ds_read_b64_tr_b16 v[130:131], v10 offset:37760
    s_waitcnt lgkmcnt(7)
    v_mfma_f32_32x32x16_bf16 v[16:31], v[132:135], v[84:87], v[16:31]
    v_mfma_f32_32x32x16_bf16 v[32:47], v[136:139], v[84:87], v[32:47]
    v_mfma_f32_32x32x16_bf16 v[48:63], v[140:143], v[84:87], v[48:63]
    ds_read_b128 v[92:95], v7 offset:49152
    v_dot2c_f32_bf16 v13, s94, v108
    v_dot2c_f32_bf16 v14, s94, v112
    v_dot2c_f32_bf16 v15, s94, v116
    v_dot2c_f32_bf16 v13, s94, v109
    v_dot2c_f32_bf16 v14, s94, v113
    v_dot2c_f32_bf16 v15, s94, v117
    v_dot2c_f32_bf16 v13, s94, v110
    v_dot2c_f32_bf16 v14, s94, v114
    v_dot2c_f32_bf16 v15, s94, v118
    v_dot2c_f32_bf16 v13, s94, v111
    v_dot2c_f32_bf16 v14, s94, v115
    v_dot2c_f32_bf16 v15, s94, v119
    v_dot2c_f32_bf16 v13, s94, v132
    v_dot2c_f32_bf16 v14, s94, v136
    v_dot2c_f32_bf16 v15, s94, v140
    v_dot2c_f32_bf16 v13, s94, v133
    v_dot2c_f32_bf16 v14, s94, v137
    v_dot2c_f32_bf16 v15, s94, v141
    v_dot2c_f32_bf16 v13, s94, v134
    v_dot2c_f32_bf16 v14, s94, v138
    v_dot2c_f32_bf16 v15, s94, v142
    v_dot2c_f32_bf16 v13, s94, v135
    v_dot2c_f32_bf16 v14, s94, v139
    v_dot2c_f32_bf16 v15, s94, v143
    ds_read_b64_tr_b16 v[132:133], v11 offset:36864
    ds_read_b64_tr_b16 v[134:135], v11 offset:37632
    ds_read_b64_tr_b16 v[136:137], v11 offset:36928
    ds_read_b64_tr_b16 v[138:139], v11 offset:37696
    ds_read_b64_tr_b16 v[140:141], v11 offset:36992
    ds_read_b64_tr_b16 v[142:143], v11 offset:37760
    ds_read_b128 v[172:175], v188 offset:0
    ds_read_b128 v[176:179], v188 offset:512
    ds_read_b128 v[180:183], v188 offset:1024
    s_waitcnt lgkmcnt(10)
    v_mfma_f32_32x32x16_bf16 v[16:31], v[120:123], v[88:91], v[16:31]
    v_mfma_f32_32x32x16_bf16 v[32:47], v[124:127], v[88:91], v[32:47]
    v_mfma_f32_32x32x16_bf16 v[48:63], v[128:131], v[88:91], v[48:63]
    s_waitcnt lgkmcnt(0)
    s_barrier
    v_mfma_f32_32x32x16_bf16 v[16:31], v[132:135], v[92:95], v[16:31]
    v_add_f32 v172, v172, v173
    v_add_f32 v174, v174, v175
    v_lshrrev_b32 v98, 16, v144
    v_mov_b32 v99, 0
    v_add_f32 v172, v172, v174
    v_mfma_f32_32x32x16_bf16 v[32:47], v[136:139], v[92:95], v[32:47]
    v_add_f32 v176, v176, v177
    v_add_f32 v178, v178, v179
    v_lshrrev_b32 v102, 16, v145
    v_mov_b32 v103, 0
    v_add_f32 v176, v176, v178
    v_mfma_f32_32x32x16_bf16 v[48:63], v[140:143], v[92:95], v[48:63]
    v_add_f32 v180, v180, v181
    v_add_f32 v182, v182, v183
    v_lshrrev_b32 v106, 16, v146
    v_mov_b32 v107, 0
    v_add_f32 v180, v180, v182
    v_dot2c_f32_bf16 v13, s94, v120
    v_dot2c_f32_bf16 v14, s94, v124
    v_dot2c_f32_bf16 v15, s94, v128
    v_dot2c_f32_bf16 v13, s94, v121
    v_dot2c_f32_bf16 v14, s94, v125
    v_dot2c_f32_bf16 v15, s94, v129
    v_dot2c_f32_bf16 v13, s94, v122
    v_dot2c_f32_bf16 v14, s94, v126
    v_dot2c_f32_bf16 v15, s94, v130
    v_dot2c_f32_bf16 v13, s94, v123
    v_dot2c_f32_bf16 v14, s94, v127
    v_dot2c_f32_bf16 v15, s94, v131
    v_dot2c_f32_bf16 v13, s94, v132
    v_dot2c_f32_bf16 v14, s94, v136
    v_dot2c_f32_bf16 v15, s94, v140
    v_dot2c_f32_bf16 v13, s94, v133
    v_dot2c_f32_bf16 v14, s94, v137
    v_dot2c_f32_bf16 v15, s94, v141
    v_dot2c_f32_bf16 v13, s94, v134
    v_dot2c_f32_bf16 v14, s94, v138
    v_dot2c_f32_bf16 v15, s94, v142
    v_dot2c_f32_bf16 v13, s94, v135
    v_dot2c_f32_bf16 v14, s94, v139
    v_dot2c_f32_bf16 v15, s94, v143
    s_nop 0
    v_mov_b32 v152, v13
    v_mov_b32 v153, v14
    v_mov_b32 v154, v15
    v_permlane32_swap_b32 v13, v152
    v_permlane32_swap_b32 v14, v153
    v_permlane32_swap_b32 v15, v154
    v_add_f32 v152, v152, v13
    v_add_f32 v153, v153, v14
    v_add_f32 v154, v154, v15
    v_add_f32 v152, v152, v172
    v_add_f32 v153, v153, v176
    v_add_f32 v154, v154, v180
    v_cvt_pk_bf16_f32 v156, 0, v152
    v_cvt_pk_bf16_f32 v157, 0, v153
    v_cvt_pk_bf16_f32 v158, 0, v154
    v_cvt_pk_bf16_f32 v97, v152, v144
    v_cvt_pk_bf16_f32 v101, v153, v145
    v_cvt_pk_bf16_f32 v105, v154, v146
    v_sub_f32 v156, v152, v156
    v_sub_f32 v157, v153, v157
    v_sub_f32 v158, v154, v158
    v_cvt_pk_bf16_f32 v96, v152, v156
    v_cvt_pk_bf16_f32 v100, v153, v157
    v_cvt_pk_bf16_f32 v104, v154, v158
    v_mfma_f32_32x32x16_bf16 v[16:31], v[96:99], v[148:151], v[16:31]
    v_mfma_f32_32x32x16_bf16 v[32:47], v[100:103], v[148:151], v[32:47]
    v_mfma_f32_32x32x16_bf16 v[48:63], v[104:107], v[148:151], v[48:63]
    s_nop 9
    v_pk_mul_f32 v[16:17], v[16:17], v[12:13] op_sel_hi:[1,0]
    v_pk_mul_f32 v[18:19], v[18:19], v[12:13] op_sel_hi:[1,0]
    v_pk_mul_f32 v[108:109], v[16:17], v[16:17]
    v_pk_mul_f32 v[110:111], v[18:19], v[18:19]
    v_pk_fma_f32 v[108:109], v[108:109], s[84:85], s[84:85] op_sel:[0,0,1] op_sel_hi:[1,0,1]
    v_pk_fma_f32 v[110:111], v[110:111], s[84:85], s[84:85] op_sel:[0,0,1] op_sel_hi:[1,0,1]
    v_pk_mul_f32 v[108:109], v[108:109], v[16:17]
    v_pk_mul_f32 v[110:111], v[110:111], v[18:19]
    v_exp_f32 v108, v108
    v_exp_f32 v109, v109
    v_exp_f32 v110, v110
    v_exp_f32 v111, v111
    v_pk_add_f32 v[108:109], v[108:109], 1.0 op_sel_hi:[1,0]
    v_pk_add_f32 v[110:111], v[110:111], 1.0 op_sel_hi:[1,0]
    v_rcp_f32 v108, v108
    v_rcp_f32 v109, v109
    v_rcp_f32 v110, v110
    v_rcp_f32 v111, v111
    v_pk_mul_f32 v[108:109], v[108:109], v[16:17]
    v_pk_mul_f32 v[110:111], v[110:111], v[18:19]
    v_cvt_pk_bf16_f32 v124, v108, v109
    v_cvt_pk_bf16_f32 v125, v110, v111
    v_pk_mul_f32 v[20:21], v[20:21], v[12:13] op_sel_hi:[1,0]
    v_pk_mul_f32 v[22:23], v[22:23], v[12:13] op_sel_hi:[1,0]
    v_pk_mul_f32 v[112:113], v[20:21], v[20:21]
    v_pk_mul_f32 v[114:115], v[22:23], v[22:23]
    v_pk_fma_f32 v[112:113], v[112:113], s[84:85], s[84:85] op_sel:[0,0,1] op_sel_hi:[1,0,1]
    v_pk_fma_f32 v[114:115], v[114:115], s[84:85], s[84:85] op_sel:[0,0,1] op_sel_hi:[1,0,1]
    v_pk_mul_f32 v[112:113], v[112:113], v[20:21]
    v_pk_mul_f32 v[114:115], v[114:115], v[22:23]
    v_exp_f32 v112, v112
    v_exp_f32 v113, v113
    v_exp_f32 v114, v114
    v_exp_f32 v115, v115
    v_pk_add_f32 v[112:113], v[112:113], 1.0 op_sel_hi:[1,0]
    v_pk_add_f32 v[114:115], v[114:115], 1.0 op_sel_hi:[1,0]
    v_rcp_f32 v112, v112
    v_rcp_f32 v113, v113
    v_rcp_f32 v114, v114
    v_rcp_f32 v115, v115
    v_pk_mul_f32 v[112:113], v[112:113], v[20:21]
    v_pk_mul_f32 v[114:115], v[114:115], v[22:23]
    v_cvt_pk_bf16_f32 v126, v112, v113
    v_cvt_pk_bf16_f32 v127, v114, v115
    buffer_store_dwordx4 v[124:127], v2, s[48:51], s88 offen offset:0 sc1
    v_pk_mul_f32 v[24:25], v[24:25], v[12:13] op_sel_hi:[1,0]
    v_pk_mul_f32 v[26:27], v[26:27], v[12:13] op_sel_hi:[1,0]
    v_pk_mul_f32 v[108:109], v[24:25], v[24:25]
    v_pk_mul_f32 v[110:111], v[26:27], v[26:27]
    v_pk_fma_f32 v[108:109], v[108:109], s[84:85], s[84:85] op_sel:[0,0,1] op_sel_hi:[1,0,1]
    v_pk_fma_f32 v[110:111], v[110:111], s[84:85], s[84:85] op_sel:[0,0,1] op_sel_hi:[1,0,1]
    v_pk_mul_f32 v[108:109], v[108:109], v[24:25]
    v_pk_mul_f32 v[110:111], v[110:111], v[26:27]
    v_exp_f32 v108, v108
    v_exp_f32 v109, v109
    v_exp_f32 v110, v110
    v_exp_f32 v111, v111
    v_pk_add_f32 v[108:109], v[108:109], 1.0 op_sel_hi:[1,0]
    v_pk_add_f32 v[110:111], v[110:111], 1.0 op_sel_hi:[1,0]
    v_rcp_f32 v108, v108
    v_rcp_f32 v109, v109
    v_rcp_f32 v110, v110
    v_rcp_f32 v111, v111
    v_pk_mul_f32 v[108:109], v[108:109], v[24:25]
    v_pk_mul_f32 v[110:111], v[110:111], v[26:27]
    v_cvt_pk_bf16_f32 v128, v108, v109
    v_cvt_pk_bf16_f32 v129, v110, v111
    v_pk_mul_f32 v[28:29], v[28:29], v[12:13] op_sel_hi:[1,0]
    v_pk_mul_f32 v[30:31], v[30:31], v[12:13] op_sel_hi:[1,0]
    v_pk_mul_f32 v[112:113], v[28:29], v[28:29]
    v_pk_mul_f32 v[114:115], v[30:31], v[30:31]
    v_pk_fma_f32 v[112:113], v[112:113], s[84:85], s[84:85] op_sel:[0,0,1] op_sel_hi:[1,0,1]
    v_pk_fma_f32 v[114:115], v[114:115], s[84:85], s[84:85] op_sel:[0,0,1] op_sel_hi:[1,0,1]
    v_pk_mul_f32 v[112:113], v[112:113], v[28:29]
    v_pk_mul_f32 v[114:115], v[114:115], v[30:31]
    v_exp_f32 v112, v112
    v_exp_f32 v113, v113
    v_exp_f32 v114, v114
    v_exp_f32 v115, v115
    v_pk_add_f32 v[112:113], v[112:113], 1.0 op_sel_hi:[1,0]
    v_pk_add_f32 v[114:115], v[114:115], 1.0 op_sel_hi:[1,0]
    v_rcp_f32 v112, v112
    v_rcp_f32 v113, v113
    v_rcp_f32 v114, v114
    v_rcp_f32 v115, v115
    v_pk_mul_f32 v[112:113], v[112:113], v[28:29]
    v_pk_mul_f32 v[114:115], v[114:115], v[30:31]
    v_cvt_pk_bf16_f32 v130, v112, v113
    v_cvt_pk_bf16_f32 v131, v114, v115
    buffer_store_dwordx4 v[128:131], v2, s[48:51], s88 offen offset:1024 sc1
    v_pk_mul_f32 v[32:33], v[32:33], v[12:13] op_sel_hi:[1,0]
    v_pk_mul_f32 v[34:35], v[34:35], v[12:13] op_sel_hi:[1,0]
    v_pk_mul_f32 v[108:109], v[32:33], v[32:33]
    v_pk_mul_f32 v[110:111], v[34:35], v[34:35]
    v_pk_fma_f32 v[108:109], v[108:109], s[84:85], s[84:85] op_sel:[0,0,1] op_sel_hi:[1,0,1]
    v_pk_fma_f32 v[110:111], v[110:111], s[84:85], s[84:85] op_sel:[0,0,1] op_sel_hi:[1,0,1]
    v_pk_mul_f32 v[108:109], v[108:109], v[32:33]
    v_pk_mul_f32 v[110:111], v[110:111], v[34:35]
    v_exp_f32 v108, v108
    v_exp_f32 v109, v109
    v_exp_f32 v110, v110
    v_exp_f32 v111, v111
    v_pk_add_f32 v[108:109], v[108:109], 1.0 op_sel_hi:[1,0]
    v_pk_add_f32 v[110:111], v[110:111], 1.0 op_sel_hi:[1,0]
    v_rcp_f32 v108, v108
    v_rcp_f32 v109, v109
    v_rcp_f32 v110, v110
    v_rcp_f32 v111, v111
    v_pk_mul_f32 v[108:109], v[108:109], v[32:33]
    v_pk_mul_f32 v[110:111], v[110:111], v[34:35]
    v_cvt_pk_bf16_f32 v124, v108, v109
    v_cvt_pk_bf16_f32 v125, v110, v111
    v_pk_mul_f32 v[36:37], v[36:37], v[12:13] op_sel_hi:[1,0]
    v_pk_mul_f32 v[38:39], v[38:39], v[12:13] op_sel_hi:[1,0]
    v_pk_mul_f32 v[112:113], v[36:37], v[36:37]
    v_pk_mul_f32 v[114:115], v[38:39], v[38:39]
    v_pk_fma_f32 v[112:113], v[112:113], s[84:85], s[84:85] op_sel:[0,0,1] op_sel_hi:[1,0,1]
    v_pk_fma_f32 v[114:115], v[114:115], s[84:85], s[84:85] op_sel:[0,0,1] op_sel_hi:[1,0,1]
    v_pk_mul_f32 v[112:113], v[112:113], v[36:37]
    v_pk_mul_f32 v[114:115], v[114:115], v[38:39]
    v_exp_f32 v112, v112
    v_exp_f32 v113, v113
    v_exp_f32 v114, v114
    v_exp_f32 v115, v115
    v_pk_add_f32 v[112:113], v[112:113], 1.0 op_sel_hi:[1,0]
    v_pk_add_f32 v[114:115], v[114:115], 1.0 op_sel_hi:[1,0]
    v_rcp_f32 v112, v112
    v_rcp_f32 v113, v113
    v_rcp_f32 v114, v114
    v_rcp_f32 v115, v115
    v_pk_mul_f32 v[112:113], v[112:113], v[36:37]
    v_pk_mul_f32 v[114:115], v[114:115], v[38:39]
    v_cvt_pk_bf16_f32 v126, v112, v113
    v_cvt_pk_bf16_f32 v127, v114, v115
    buffer_store_dwordx4 v[124:127], v2, s[48:51], s89 offen offset:0 sc1
    v_pk_mul_f32 v[40:41], v[40:41], v[12:13] op_sel_hi:[1,0]
    v_pk_mul_f32 v[42:43], v[42:43], v[12:13] op_sel_hi:[1,0]
    v_pk_mul_f32 v[108:109], v[40:41], v[40:41]
    v_pk_mul_f32 v[110:111], v[42:43], v[42:43]
    v_pk_fma_f32 v[108:109], v[108:109], s[84:85], s[84:85] op_sel:[0,0,1] op_sel_hi:[1,0,1]
    v_pk_fma_f32 v[110:111], v[110:111], s[84:85], s[84:85] op_sel:[0,0,1] op_sel_hi:[1,0,1]
    v_pk_mul_f32 v[108:109], v[108:109], v[40:41]
    v_pk_mul_f32 v[110:111], v[110:111], v[42:43]
    v_exp_f32 v108, v108
    v_exp_f32 v109, v109
    v_exp_f32 v110, v110
    v_exp_f32 v111, v111
    v_pk_add_f32 v[108:109], v[108:109], 1.0 op_sel_hi:[1,0]
    v_pk_add_f32 v[110:111], v[110:111], 1.0 op_sel_hi:[1,0]
    v_rcp_f32 v108, v108
    v_rcp_f32 v109, v109
    v_rcp_f32 v110, v110
    v_rcp_f32 v111, v111
    v_pk_mul_f32 v[108:109], v[108:109], v[40:41]
    v_pk_mul_f32 v[110:111], v[110:111], v[42:43]
    v_cvt_pk_bf16_f32 v128, v108, v109
    v_cvt_pk_bf16_f32 v129, v110, v111
    v_pk_mul_f32 v[44:45], v[44:45], v[12:13] op_sel_hi:[1,0]
    v_pk_mul_f32 v[46:47], v[46:47], v[12:13] op_sel_hi:[1,0]
    v_pk_mul_f32 v[112:113], v[44:45], v[44:45]
    v_pk_mul_f32 v[114:115], v[46:47], v[46:47]
    v_pk_fma_f32 v[112:113], v[112:113], s[84:85], s[84:85] op_sel:[0,0,1] op_sel_hi:[1,0,1]
    v_pk_fma_f32 v[114:115], v[114:115], s[84:85], s[84:85] op_sel:[0,0,1] op_sel_hi:[1,0,1]
    v_pk_mul_f32 v[112:113], v[112:113], v[44:45]
    v_pk_mul_f32 v[114:115], v[114:115], v[46:47]
    v_exp_f32 v112, v112
    v_exp_f32 v113, v113
    v_exp_f32 v114, v114
    v_exp_f32 v115, v115
    v_pk_add_f32 v[112:113], v[112:113], 1.0 op_sel_hi:[1,0]
    v_pk_add_f32 v[114:115], v[114:115], 1.0 op_sel_hi:[1,0]
    v_rcp_f32 v112, v112
    v_rcp_f32 v113, v113
    v_rcp_f32 v114, v114
    v_rcp_f32 v115, v115
    v_pk_mul_f32 v[112:113], v[112:113], v[44:45]
    v_pk_mul_f32 v[114:115], v[114:115], v[46:47]
    v_cvt_pk_bf16_f32 v130, v112, v113
    v_cvt_pk_bf16_f32 v131, v114, v115
    buffer_store_dwordx4 v[128:131], v2, s[48:51], s89 offen offset:1024 sc1
    v_pk_mul_f32 v[48:49], v[48:49], v[12:13] op_sel_hi:[1,0]
    v_pk_mul_f32 v[50:51], v[50:51], v[12:13] op_sel_hi:[1,0]
    v_pk_mul_f32 v[108:109], v[48:49], v[48:49]
    v_pk_mul_f32 v[110:111], v[50:51], v[50:51]
    v_pk_fma_f32 v[108:109], v[108:109], s[84:85], s[84:85] op_sel:[0,0,1] op_sel_hi:[1,0,1]
    v_pk_fma_f32 v[110:111], v[110:111], s[84:85], s[84:85] op_sel:[0,0,1] op_sel_hi:[1,0,1]
    v_pk_mul_f32 v[108:109], v[108:109], v[48:49]
    v_pk_mul_f32 v[110:111], v[110:111], v[50:51]
    v_exp_f32 v108, v108
    v_exp_f32 v109, v109
    v_exp_f32 v110, v110
    v_exp_f32 v111, v111
    v_pk_add_f32 v[108:109], v[108:109], 1.0 op_sel_hi:[1,0]
    v_pk_add_f32 v[110:111], v[110:111], 1.0 op_sel_hi:[1,0]
    v_rcp_f32 v108, v108
    v_rcp_f32 v109, v109
    v_rcp_f32 v110, v110
    v_rcp_f32 v111, v111
    v_pk_mul_f32 v[108:109], v[108:109], v[48:49]
    v_pk_mul_f32 v[110:111], v[110:111], v[50:51]
    v_cvt_pk_bf16_f32 v124, v108, v109
    v_cvt_pk_bf16_f32 v125, v110, v111
    v_pk_mul_f32 v[52:53], v[52:53], v[12:13] op_sel_hi:[1,0]
    v_pk_mul_f32 v[54:55], v[54:55], v[12:13] op_sel_hi:[1,0]
    v_pk_mul_f32 v[112:113], v[52:53], v[52:53]
    v_pk_mul_f32 v[114:115], v[54:55], v[54:55]
    v_pk_fma_f32 v[112:113], v[112:113], s[84:85], s[84:85] op_sel:[0,0,1] op_sel_hi:[1,0,1]
    v_pk_fma_f32 v[114:115], v[114:115], s[84:85], s[84:85] op_sel:[0,0,1] op_sel_hi:[1,0,1]
    v_pk_mul_f32 v[112:113], v[112:113], v[52:53]
    v_pk_mul_f32 v[114:115], v[114:115], v[54:55]
    v_exp_f32 v112, v112
    v_exp_f32 v113, v113
    v_exp_f32 v114, v114
    v_exp_f32 v115, v115
    v_pk_add_f32 v[112:113], v[112:113], 1.0 op_sel_hi:[1,0]
    v_pk_add_f32 v[114:115], v[114:115], 1.0 op_sel_hi:[1,0]
    v_rcp_f32 v112, v112
    v_rcp_f32 v113, v113
    v_rcp_f32 v114, v114
    v_rcp_f32 v115, v115
    v_pk_mul_f32 v[112:113], v[112:113], v[52:53]
    v_pk_mul_f32 v[114:115], v[114:115], v[54:55]
    v_cvt_pk_bf16_f32 v126, v112, v113
    v_cvt_pk_bf16_f32 v127, v114, v115
    buffer_store_dwordx4 v[124:127], v2, s[48:51], s89 offen offset:2048 sc1
    s_waitcnt vmcnt(2)
    s_mov_b64 exec, 1
    buffer_store_dword v147, off, s[48:51], s68 sc1
    s_mov_b64 exec, -1
    v_pk_mul_f32 v[56:57], v[56:57], v[12:13] op_sel_hi:[1,0]
    v_pk_mul_f32 v[58:59], v[58:59], v[12:13] op_sel_hi:[1,0]
    v_pk_mul_f32 v[108:109], v[56:57], v[56:57]
    v_pk_mul_f32 v[110:111], v[58:59], v[58:59]
    v_pk_fma_f32 v[108:109], v[108:109], s[84:85], s[84:85] op_sel:[0,0,1] op_sel_hi:[1,0,1]
    v_pk_fma_f32 v[110:111], v[110:111], s[84:85], s[84:85] op_sel:[0,0,1] op_sel_hi:[1,0,1]
    v_pk_mul_f32 v[108:109], v[108:109], v[56:57]
    v_pk_mul_f32 v[110:111], v[110:111], v[58:59]
    v_exp_f32 v108, v108
    v_exp_f32 v109, v109
    v_exp_f32 v110, v110
    v_exp_f32 v111, v111
    v_pk_add_f32 v[108:109], v[108:109], 1.0 op_sel_hi:[1,0]
    v_pk_add_f32 v[110:111], v[110:111], 1.0 op_sel_hi:[1,0]
    v_rcp_f32 v108, v108
    v_rcp_f32 v109, v109
    v_rcp_f32 v110, v110
    v_rcp_f32 v111, v111
    v_pk_mul_f32 v[108:109], v[108:109], v[56:57]
    v_pk_mul_f32 v[110:111], v[110:111], v[58:59]
    v_cvt_pk_bf16_f32 v128, v108, v109
    v_cvt_pk_bf16_f32 v129, v110, v111
    v_pk_mul_f32 v[60:61], v[60:61], v[12:13] op_sel_hi:[1,0]
    v_pk_mul_f32 v[62:63], v[62:63], v[12:13] op_sel_hi:[1,0]
    v_pk_mul_f32 v[112:113], v[60:61], v[60:61]
    v_pk_mul_f32 v[114:115], v[62:63], v[62:63]
    v_pk_fma_f32 v[112:113], v[112:113], s[84:85], s[84:85] op_sel:[0,0,1] op_sel_hi:[1,0,1]
    v_pk_fma_f32 v[114:115], v[114:115], s[84:85], s[84:85] op_sel:[0,0,1] op_sel_hi:[1,0,1]
    v_pk_mul_f32 v[112:113], v[112:113], v[60:61]
    v_pk_mul_f32 v[114:115], v[114:115], v[62:63]
    v_exp_f32 v112, v112
    v_exp_f32 v113, v113
    v_exp_f32 v114, v114
    v_exp_f32 v115, v115
    v_pk_add_f32 v[112:113], v[112:113], 1.0 op_sel_hi:[1,0]
    v_pk_add_f32 v[114:115], v[114:115], 1.0 op_sel_hi:[1,0]
    v_rcp_f32 v112, v112
    v_rcp_f32 v113, v113
    v_rcp_f32 v114, v114
    v_rcp_f32 v115, v115
    v_pk_mul_f32 v[112:113], v[112:113], v[60:61]
    v_pk_mul_f32 v[114:115], v[114:115], v[62:63]
    v_cvt_pk_bf16_f32 v130, v112, v113
    v_cvt_pk_bf16_f32 v131, v114, v115
    buffer_store_dwordx4 v[128:131], v2, s[48:51], s89 offen offset:3072 sc1
    s_lshl_b32 s91, s63, 12
    s_add_u32 s91, s91, 131072
    v_and_b32 v4, 31, v1
    v_lshl_add_u32 v4, v4, 7, s91
    v_lshrrev_b32 v64, 4, v1
    v_and_b32 v64, 1, v64
    v_lshlrev_b32 v64, 2, v64
    v_and_b32 v65, 7, v1
    v_xor_b32 v64, v64, v65
    v_lshlrev_b32 v64, 4, v64
    v_lshrrev_b32 v65, 3, v1
    v_lshl_add_u32 v146, v65, 10, v64
    s_mul_i32 s82, s60, 98304
    s_lshl_b32 s90, s64, 7
    s_add_u32 s82, s82, s90
    s_mov_b64 s[44:45], s[24:25]
    s_mov_b32 s46, 1409024
    s_mov_b32 s47, 0x20000
    s_lshl_b32 s90, s60, 2
    s_add_u32 s90, s90, 162752
    v_mov_b32 v15, s90
    v_lshrrev_b32 v64, 5, v1
    v_bfe_u32 v65, v1, 2, 2
    v_lshl_add_u32 v65, v64, 2, v65
    v_bfe_u32 v66, v1, 3, 1
    s_and_b32 s90, s60, 1
    v_xor_b32 v66, s90, v66
    v_lshlrev_b32 v66, 6, v66
    v_lshl_add_u32 v66, v65, 7, v66
    v_bfe_u32 v67, v1, 4, 1
    v_lshl_add_u32 v66, v67, 5, v66
    v_and_b32 v68, 3, v1
    v_lshl_add_u32 v66, v68, 3, v66
    v_add_u32 v148, s65, v66
    v_xor_b32 v149, 64, v148
    v_add_u32 v150, s95, v66
    v_xor_b32 v151, 64, v150
Llw_15:
    ds_read_b32 v69, v15 offset:32
    s_waitcnt lgkmcnt(0)
    v_cmp_eq_u32 vcc, 1, v69
    s_cbranch_vccz Llw_15
    ds_read_b64_tr_b16 a[0:1], v148 offset:0
    ds_read_b64_tr_b16 a[2:3], v148 offset:1024
    ds_read_b64_tr_b16 a[4:5], v149 offset:0
    ds_read_b64_tr_b16 a[6:7], v149 offset:1024
    ds_read_b64_tr_b16 a[8:9], v148 offset:2048
    ds_read_b64_tr_b16 a[10:11], v148 offset:3072
    ds_read_b64_tr_b16 a[12:13], v149 offset:2048
    ds_read_b64_tr_b16 a[14:15], v149 offset:3072
    ds_read_b64_tr_b16 a[16:17], v150 offset:0
    ds_read_b64_tr_b16 a[18:19], v150 offset:1024
    ds_read_b64_tr_b16 a[20:21], v151 offset:0
    ds_read_b64_tr_b16 a[22:23], v151 offset:1024
    ds_read_b64_tr_b16 a[24:25], v150 offset:2048
    ds_read_b64_tr_b16 a[26:27], v148 offset:16384
    ds_read_b64_tr_b16 a[28:29], v151 offset:2048
    ds_read_b64_tr_b16 a[30:31], v149 offset:16384
    ds_read_b64_tr_b16 a[32:33], v148 offset:17408
    ds_read_b64_tr_b16 a[34:35], v148 offset:18432
    ds_read_b64_tr_b16 a[36:37], v149 offset:17408
    ds_read_b64_tr_b16 a[38:39], v149 offset:18432
    ds_read_b64_tr_b16 a[40:41], v148 offset:19456
    ds_read_b64_tr_b16 a[42:43], v150 offset:12288
    ds_read_b64_tr_b16 a[44:45], v149 offset:19456
    ds_read_b64_tr_b16 a[46:47], v151 offset:12288
    ds_read_b64_tr_b16 a[48:49], v150 offset:13312
    ds_read_b64_tr_b16 a[50:51], v150 offset:14336
    ds_read_b64_tr_b16 a[52:53], v151 offset:13312
    ds_read_b64_tr_b16 a[54:55], v151 offset:14336
    ds_read_b64_tr_b16 a[56:57], v148 offset:32768
    ds_read_b64_tr_b16 a[58:59], v148 offset:33792
    ds_read_b64_tr_b16 a[60:61], v149 offset:32768
    ds_read_b64_tr_b16 a[62:63], v149 offset:33792
    s_waitcnt lgkmcnt(0)
    s_and_b32 s90, s60, 1
    s_lshl_b32 s91, s64, 1
    s_add_u32 s90, s90, s91
    s_lshl_b32 s78, s90, 6
    s_lshr_b32 s92, s60, 1
    s_lshl_b32 s91, s63, 1
    s_add_u32 s92, s91, s92
    s_lshl_b32 s79, s92, 15
    s_add_u32 m0, s65, 0
    s_add_u32 s83, s82, 1228800
    s_cmp_ge_u32 s60, 2
    s_cselect_b32 s101, 4293607424, 0
    s_add_u32 s83, s83, s101
    buffer_load_dwordx4 v146, s[44:47], s83 offen offset:0 lds
    s_add_u32 s79, s79, s78
    s_lshl_b32 s76, s90, 17
    s_lshl_b32 s91, s92, 6
    s_add_u32 s76, s76, s91
    s_add_u32 s76, s76, 2621440
    s_mul_i32 s93, s60, 6
    s_mul_i32 s88, s92, 86
    s_add_u32 s88, s88, s93
    s_add_u32 s83, s82, 1235968
    s_cmp_ge_u32 s60, 2
    s_cselect_b32 s101, 4293607424, 0
    s_add_u32 s83, s83, s101
    buffer_load_dwordx4 v146, s[44:47], s83 offen offset:1024 lds
    s_lshl_b32 s88, s88, 10
    s_add_u32 s88, s88, 4718592
    s_xor_b32 s92, s92, 1
    s_mul_i32 s89, s92, 86
    s_add_u32 s89, s89, s93
    s_lshl_b32 s89, s89, 10
    s_add_u32 s89, s89, 4718592
    s_add_u32 s83, s82, 260096
    buffer_load_dwordx4 v146, s[44:47], s83 offen offset:2048 lds
    v_and_b32 v69, 15, v1
    v_lshlrev_b32 v69, 7, v69
    v_add_u32 v188, 0x20000, v4
    s_lshl_b32 s90, s90, 11
    s_add_u32 s90, s90, 0
    v_add_u32 v5, s90, v69
    v_lshlrev_b32 v70, 3, v64
    v_add_u32 v6, s78, v70
    s_add_u32 s83, s82, 267264
    buffer_load_dwordx4 v146, s[44:47], s83 offen offset:3072 lds
    v_and_b32 v71, 31, v1
    v_lshlrev_b32 v7, 10, v71
    v_lshl_add_u32 v7, v64, 4, v7
    v_lshrrev_b32 v72, 2, v1
    v_lshlrev_b32 v73, 4, v68
    v_lshl_add_u32 v8, v72, 10, v73
    v_lshl_add_u32 v9, v72, 12, v73
    s_add_u32 s90, s95, 24576
    s_add_u32 m0, s95, 0
    s_add_u32 s83, s82, 655360
    buffer_load_dwordx4 v146, s[44:47], s83 offen offset:0 lds
    v_mul_u32_u24 v72, 80, v72
    v_add3_u32 v10, v72, v73, s90
    v_mul_u32_u24 v71, 80, v71
    v_add3_u32 v11, v71, v70, s90
    v_add_u32 v12, s90, v2
    v_lshlrev_b32 v65, 6, v65
    v_lshl_add_u32 v65, v67, 5, v65
    s_add_u32 s83, s82, 662528
    buffer_load_dwordx4 v146, s[44:47], s83 offen offset:1024 lds
    v_lshl_add_u32 v65, v68, 3, v65
    v_add_u32 v13, s90, v65
    v_add_u32 v184, s65, v2
    s_mov_b64 s[52:53], s[28:29]
    s_mov_b32 s54, 2097152
    s_mov_b32 s55, 0x20000
    s_xor_b32 s90, s60, 1
    s_lshl_b32 s90, s90, 12
    s_add_u32 s83, s82, 1046528
    buffer_load_dwordx4 v146, s[44:47], s83 offen offset:2048 lds
    v_add_u32 v185, s90, v2
    s_xor_b32 s90, s60, 2
    s_lshl_b32 s90, s90, 12
    v_add_u32 v186, s90, v2
    s_xor_b32 s90, s60, 3
    s_lshl_b32 s90, s90, 12
    v_add_u32 v187, s90, v2
    s_add_u32 m0, s65, 16384
    s_add_u32 s83, s82, 1056768
    buffer_load_dwordx4 v146, s[44:47], s83 offen offset:0 lds
    global_load_dwordx2 v[160:161], v6, s[26:27] offset:0
    global_load_dwordx2 v[162:163], v6, s[26:27] offset:16
    global_load_dwordx2 v[164:165], v6, s[26:27] offset:32
    global_load_dwordx2 v[166:167], v6, s[26:27] offset:48
    s_cmp_eq_u32 s60, 0
    s_cselect_b32 s90, 0, 268435456
    buffer_load_dword v14, v4, s[48:51], s90 offen sc1
    s_waitcnt vmcnt(13)
    s_mov_b64 exec, 1
    s_add_u32 s68, s68, 0x20000
    buffer_store_dword v147, off, s[48:51], s68 sc1
    s_mov_b64 exec, -1
    v_mov_b32 v15, 162752
    s_cmp_eq_u32 s60, 0
    s_cbranch_scc0 Loth_16
    s_waitcnt vmcnt(1)
    v_cmp_ne_u32 vcc, v147, v14
    s_mov_b32 s87, 0
    s_cmp_eq_u64 vcc, 0
    s_cbranch_scc1 Lok_18
Lspin_19:
    buffer_load_dword v14, v4, s[48:51], 0 offen sc1
    s_add_u32 s87, s87, 1
    s_waitcnt vmcnt(0)
    v_cmp_ne_u32 vcc, v147, v14
    s_cmp_gt_u32 s87, 262144
    s_cbranch_scc1 Lok_18
    s_cmp_eq_u64 vcc, 0
    s_cbranch_scc0 Lspin_19
Lok_18:
    ds_write_b32 v15, v3 offset:96
    s_waitcnt lgkmcnt(0)
    s_branch Lsp_17
Loth_16:
Llw_20:
    ds_read_b32 v14, v15 offset:96
    s_waitcnt lgkmcnt(0)
    v_cmp_eq_u32 vcc, 1, v14
    s_cbranch_vccz Llw_20
Lsp_17:
    s_add_u32 s3, s88, 0
    buffer_load_dwordx4 v[80:83], v2, s[48:51], s3 offen sc1
    s_add_u32 s3, s89, 0
    buffer_load_dwordx4 v[84:87], v2, s[48:51], s3 offen sc1
    s_add_u32 s3, s88, 24576
    buffer_load_dwordx4 v[88:91], v2, s[48:51], s3 offen sc1
    s_add_u32 s3, s89, 24576
    buffer_load_dwordx4 v[92:95], v2, s[48:51], s3 offen sc1
    s_add_u32 s3, s88, 49152
    buffer_load_dwordx4 v[96:99], v2, s[48:51], s3 offen sc1
    s_add_u32 s3, s89, 49152
    buffer_load_dwordx4 v[100:103], v2, s[48:51], s3 offen sc1
    s_add_u32 s3, s88, 73728
    s_cmp_ge_u32 s60, 3
    s_cselect_b32 s101, 4294876160, 0
    s_add_u32 s3, s3, s101
    buffer_load_dwordx4 v[104:107], v2, s[48:51], s3 offen sc1
    s_add_u32 s3, s89, 73728
    s_cmp_ge_u32 s60, 3
    s_cselect_b32 s101, 4294876160, 0
    s_add_u32 s3, s3, s101
    buffer_load_dwordx4 v[108:111], v2, s[48:51], s3 offen sc1
    s_add_u32 s3, s88, 7168
    buffer_load_dwordx4 v[112:115], v2, s[48:51], s3 offen sc1
    s_add_u32 s3, s89, 7168
    buffer_load_dwordx4 v[116:119], v2, s[48:51], s3 offen sc1
    s_add_u32 s3, s88, 31744
    buffer_load_dwordx4 v[120:123], v2, s[48:51], s3 offen sc1
    s_add_u32 s3, s89, 31744
    buffer_load_dwordx4 v[124:127], v2, s[48:51], s3 offen sc1
    ds_read_b64_tr_b16 v[152:153], v148 offset:34816
    ds_read_b64_tr_b16 v[154:155], v148 offset:35840
    ds_read_b64_tr_b16 v[156:157], v149 offset:34816
    ds_read_b64_tr_b16 v[158:159], v149 offset:35840
    ds_read_b64_tr_b16 v[128:129], v150 offset:24576
    ds_read_b64_tr_b16 v[130:131], v150 offset:25600
    ds_read_b64_tr_b16 v[132:133], v151 offset:24576
    ds_read_b64_tr_b16 v[134:135], v151 offset:25600
    s_waitcnt vmcnt(14)
    v_lshlrev_b32 v16, 16, v160
    v_and_b32 v17, 0xffff0000, v160
    v_lshlrev_b32 v18, 16, v161
    v_and_b32 v19, 0xffff0000, v161
    v_lshlrev_b32 v20, 16, v162
    v_and_b32 v21, 0xffff0000, v162
    v_lshlrev_b32 v22, 16, v163
    v_and_b32 v23, 0xffff0000, v163
    v_lshlrev_b32 v24, 16, v164
    v_and_b32 v25, 0xffff0000, v164
    v_lshlrev_b32 v26, 16, v165
    v_and_b32 v27, 0xffff0000, v165
    v_lshlrev_b32 v28, 16, v166
    v_and_b32 v29, 0xffff0000, v166
    v_lshlrev_b32 v30, 16, v167
    v_and_b32 v31, 0xffff0000, v167
    s_waitcnt vmcnt(10)
    s_nop 0
    v_mfma_f32_32x32x16_bf16 v[16:31], a[0:3], v[80:83], v[16:31]
    s_add_u32 s83, s82, 80896
    buffer_load_dwordx4 v146, s[44:47], s83 offen offset:1024 lds
    v_mfma_f32_32x32x16_bf16 v[32:47], a[4:7], v[80:83], 0
    s_add_u32 s3, s88, 56320
    buffer_load_dwordx4 v[80:83], v2, s[48:51], s3 offen sc1
    v_mfma_f32_32x32x16_bf16 v[48:63], a[0:3], v[84:87], 0
    v_mfma_f32_32x32x16_bf16 v[64:79], a[4:7], v[84:87], 0
    s_add_u32 s3, s89, 56320
    buffer_load_dwordx4 v[84:87], v2, s[48:51], s3 offen sc1
    s_waitcnt vmcnt(11)
    s_cmp_eq_u32 s60, 0
    s_cselect_b32 s90, 0, 268435456
    buffer_load_dword v189, v188, s[48:51], s90 offen sc1
    v_mfma_f32_32x32x16_bf16 v[16:31], a[8:11], v[88:91], v[16:31]
    s_add_u32 s83, s82, 88064
    buffer_load_dwordx4 v146, s[44:47], s83 offen offset:2048 lds
    v_mfma_f32_32x32x16_bf16 v[32:47], a[12:15], v[88:91], v[32:47]
    s_add_u32 s3, s88, 80896
    s_cmp_ge_u32 s60, 2
    s_cselect_b32 s101, 4294876160, 0
    s_add_u32 s3, s3, s101
    buffer_load_dwordx4 v[88:91], v2, s[48:51], s3 offen sc1
    v_mfma_f32_32x32x16_bf16 v[48:63], a[8:11], v[92:95], v[48:63]
    v_mfma_f32_32x32x16_bf16 v[64:79], a[12:15], v[92:95], v[64:79]
    s_add_u32 s3, s89, 80896
    s_cmp_ge_u32 s60, 2
    s_cselect_b32 s101, 4294876160, 0
    s_add_u32 s3, s3, s101
    buffer_load_dwordx4 v[92:95], v2, s[48:51], s3 offen sc1
    s_waitcnt vmcnt(13)
    v_mfma_f32_32x32x16_bf16 v[16:31], a[16:19], v[96:99], v[16:31]
    s_add_u32 s83, s82, 472064
    buffer_load_dwordx4 v146, s[44:47], s83 offen offset:3072 lds
    v_mfma_f32_32x32x16_bf16 v[32:47], a[20:23], v[96:99], v[32:47]
    s_add_u32 s3, s88, 14336
    buffer_load_dwordx4 v[96:99], v2, s[48:51], s3 offen sc1
    v_mfma_f32_32x32x16_bf16 v[48:63], a[16:19], v[100:103], v[48:63]
    v_mfma_f32_32x32x16_bf16 v[64:79], a[20:23], v[100:103], v[64:79]
    s_add_u32 s3, s89, 14336
    buffer_load_dwordx4 v[100:103], v2, s[48:51], s3 offen sc1
    s_add_u32 s91, s79, 16384
    buffer_load_dwordx4 v[168:171], v8, s[36:39], s79 offen
    buffer_load_dwordx4 v[172:175], v8, s[36:39], s91 offen
    s_waitcnt vmcnt(16)
    v_mfma_f32_32x32x16_bf16 v[16:31], a[24:27], v[104:107], v[16:31]
    s_add_u32 m0, s95, 12288
    s_add_u32 s83, s82, 483328
    buffer_load_dwordx4 v146, s[44:47], s83 offen offset:0 lds
    v_mfma_f32_32x32x16_bf16 v[32:47], a[28:31], v[104:107], v[32:47]
    s_add_u32 s3, s88, 38912
    buffer_load_dwordx4 v[104:107], v2, s[48:51], s3 offen sc1
    v_mfma_f32_32x32x16_bf16 v[48:63], a[24:27], v[108:111], v[48:63]
    v_mfma_f32_32x32x16_bf16 v[64:79], a[28:31], v[108:111], v[64:79]
    s_add_u32 s3, s89, 38912
    buffer_load_dwordx4 v[108:111], v2, s[48:51], s3 offen sc1
    s_waitcnt vmcnt(17)
    v_mfma_f32_32x32x16_bf16 v[16:31], a[32:35], v[112:115], v[16:31]
    s_add_u32 s83, s82, 867328
    buffer_load_dwordx4 v146, s[44:47], s83 offen offset:1024 lds
    v_mfma_f32_32x32x16_bf16 v[32:47], a[36:39], v[112:115], v[32:47]
    s_add_u32 s3, s88, 63488
    buffer_load_dwordx4 v[112:115], v2, s[48:51], s3 offen sc1
    v_mfma_f32_32x32x16_bf16 v[48:63], a[32:35], v[116:119], v[48:63]
    v_mfma_f32_32x32x16_bf16 v[64:79], a[36:39], v[116:119], v[64:79]
    s_add_u32 s3, s89, 63488
    buffer_load_dwordx4 v[116:119], v2, s[48:51], s3 offen sc1
    s_waitcnt vmcnt(18)
    v_mov_b32 v15, 162752
    s_cmp_eq_u32 s60, 0
    s_cbranch_scc0 Loth_21
    s_waitcnt vmcnt(14)
    v_cmp_ne_u32 vcc, v147, v189
    s_mov_b32 s87, 0
    s_cmp_eq_u64 vcc, 0
    s_cbranch_scc1 Lok_23
Lspin_24:
    buffer_load_dword v189, v188, s[48:51], 0 offen sc1
    s_add_u32 s87, s87, 1
    s_waitcnt vmcnt(0)
    v_cmp_ne_u32 vcc, v147, v189
    s_cmp_gt_u32 s87, 262144
    s_cbranch_scc1 Lok_23
    s_cmp_eq_u64 vcc, 0
    s_cbranch_scc0 Lspin_24
Lok_23:
    ds_write_b32 v15, v3 offset:112
    s_waitcnt lgkmcnt(0)
    s_branch Lsp_22
Loth_21:
Llw_25:
    ds_read_b32 v189, v15 offset:112
    s_waitcnt lgkmcnt(0)
    v_cmp_eq_u32 vcc, 1, v189
    s_cbranch_vccz Llw_25
Lsp_22:
    v_mfma_f32_32x32x16_bf16 v[16:31], a[40:43], v[120:123], v[16:31]
    s_add_u32 s83, s82, 874496
    buffer_load_dwordx4 v146, s[44:47], s83 offen offset:2048 lds
    v_mfma_f32_32x32x16_bf16 v[32:47], a[44:47], v[120:123], v[32:47]
    s_add_u32 s3, s88, 3072
    buffer_load_dwordx4 v[120:123], v2, s[48:51], s3 offen sc1
    v_mfma_f32_32x32x16_bf16 v[48:63], a[40:43], v[124:127], v[48:63]
    v_mfma_f32_32x32x16_bf16 v[64:79], a[44:47], v[124:127], v[64:79]
    s_add_u32 s3, s89, 3072
    buffer_load_dwordx4 v[124:127], v2, s[48:51], s3 offen sc1
    s_waitcnt vmcnt(18)
    v_mfma_f32_32x32x16_bf16 v[16:31], a[48:51], v[80:83], v[16:31]
    s_add_u32 m0, s65, 32768
    s_add_u32 s83, s82, 1261568
    s_cmp_ge_u32 s60, 2
    s_cselect_b32 s101, 4194304, 0
    s_add_u32 s83, s83, s101
    buffer_load_dwordx4 v146, s[44:47], s83 offen offset:0 lds
    v_mfma_f32_32x32x16_bf16 v[32:47], a[52:55], v[80:83], v[32:47]
    s_add_u32 s3, s88, 27648
    buffer_load_dwordx4 v[80:83], v2, s[48:51], s3 offen sc1
    v_mfma_f32_32x32x16_bf16 v[48:63], a[48:51], v[84:87], v[48:63]
    v_mfma_f32_32x32x16_bf16 v[64:79], a[52:55], v[84:87], v[64:79]
    s_add_u32 s3, s89, 27648
    buffer_load_dwordx4 v[84:87], v2, s[48:51], s3 offen sc1
    s_waitcnt vmcnt(17)
    v_mfma_f32_32x32x16_bf16 v[16:31], a[56:59], v[88:91], v[16:31]
    s_add_u32 s83, s82, 1268736
    s_cmp_ge_u32 s60, 2
    s_cselect_b32 s101, 4194304, 0
    s_add_u32 s83, s83, s101
    buffer_load_dwordx4 v146, s[44:47], s83 offen offset:1024 lds
    v_mfma_f32_32x32x16_bf16 v[32:47], a[60:63], v[88:91], v[32:47]
    s_add_u32 s3, s88, 52224
    buffer_load_dwordx4 v[88:91], v2, s[48:51], s3 offen sc1
    v_mfma_f32_32x32x16_bf16 v[48:63], a[56:59], v[92:95], v[48:63]
    v_mfma_f32_32x32x16_bf16 v[64:79], a[60:63], v[92:95], v[64:79]
    s_add_u32 s3, s89, 52224
    buffer_load_dwordx4 v[92:95], v2, s[48:51], s3 offen sc1
    s_waitcnt vmcnt(17)
    v_mfma_f32_32x32x16_bf16 v[16:31], v[152:155], v[96:99], v[16:31]
    ds_read_b64_tr_b16 v[136:137], v150 offset:26624
    ds_read_b64_tr_b16 v[138:139], v148 offset:49152
    v_mfma_f32_32x32x16_bf16 v[32:47], v[156:159], v[96:99], v[32:47]
    s_add_u32 s3, s88, 76800
    s_cmp_ge_u32 s60, 2
    s_cselect_b32 s101, 4294882304, 0
    s_add_u32 s3, s3, s101
    buffer_load_dwordx4 v[96:99], v2, s[48:51], s3 offen sc1
    v_mfma_f32_32x32x16_bf16 v[48:63], v[152:155], v[100:103], v[48:63]
    ds_read_b64_tr_b16 v[140:141], v151 offset:26624
    ds_read_b64_tr_b16 v[142:143], v149 offset:49152
    v_mfma_f32_32x32x16_bf16 v[64:79], v[156:159], v[100:103], v[64:79]
    s_add_u32 s3, s89, 76800
    s_cmp_ge_u32 s60, 2
    s_cselect_b32 s101, 4294882304, 0
    s_add_u32 s3, s3, s101
    buffer_load_dwordx4 v[100:103], v2, s[48:51], s3 offen sc1
    s_waitcnt vmcnt(14)
    v_mfma_f32_32x32x16_bf16 v[16:31], v[128:131], v[104:107], v[16:31]
    ds_read_b64_tr_b16 v[152:153], v148 offset:50176
    ds_read_b64_tr_b16 v[154:155], v148 offset:51200
    v_mfma_f32_32x32x16_bf16 v[32:47], v[132:135], v[104:107], v[32:47]
    s_add_u32 s3, s88, 16384
    buffer_load_dwordx4 v[104:107], v2, s[48:51], s3 offen sc1
    v_mfma_f32_32x32x16_bf16 v[48:63], v[128:131], v[108:111], v[48:63]
    ds_read_b64_tr_b16 v[156:157], v149 offset:50176
    ds_read_b64_tr_b16 v[158:159], v149 offset:51200
    v_mfma_f32_32x32x16_bf16 v[64:79], v[132:135], v[108:111], v[64:79]
    s_add_u32 s3, s89, 16384
    buffer_load_dwordx4 v[108:111], v2, s[48:51], s3 offen sc1
    s_waitcnt vmcnt(13) lgkmcnt(4)
    v_mfma_f32_32x32x16_bf16 v[16:31], v[136:139], v[112:115], v[16:31]
    ds_read_b64_tr_b16 v[128:129], v148 offset:52224
    ds_read_b64_tr_b16 v[130:131], v150 offset:36864
    v_mfma_f32_32x32x16_bf16 v[32:47], v[140:143], v[112:115], v[32:47]
    s_add_u32 s3, s88, 40960
    buffer_load_dwordx4 v[112:115], v2, s[48:51], s3 offen sc1
    v_mfma_f32_32x32x16_bf16 v[48:63], v[136:139], v[116:119], v[48:63]
    ds_read_b64_tr_b16 v[132:133], v149 offset:52224
    ds_read_b64_tr_b16 v[134:135], v151 offset:36864
    v_mfma_f32_32x32x16_bf16 v[64:79], v[140:143], v[116:119], v[64:79]
    s_add_u32 s3, s89, 40960
    buffer_load_dwordx4 v[116:119], v2, s[48:51], s3 offen sc1
    s_waitcnt vmcnt(12) lgkmcnt(4)
    s_waitcnt vmcnt(8)
    v_mfma_f32_32x32x16_bf16 v[16:31], v[152:155], v[120:123], v[16:31]
    ds_read_b64_tr_b16 v[136:137], v150 offset:37888
    ds_read_b64_tr_b16 v[138:139], v150 offset:38912
    v_mfma_f32_32x32x16_bf16 v[32:47], v[156:159], v[120:123], v[32:47]
    s_add_u32 s3, s88, 65536
    buffer_load_dwordx4 v[120:123], v2, s[48:51], s3 offen sc1
    v_mfma_f32_32x32x16_bf16 v[48:63], v[152:155], v[124:127], v[48:63]
    ds_read_b64_tr_b16 v[140:141], v151 offset:37888
    ds_read_b64_tr_b16 v[142:143], v151 offset:38912
    v_mfma_f32_32x32x16_bf16 v[64:79], v[156:159], v[124:127], v[64:79]
    s_add_u32 s3, s89, 65536
    buffer_load_dwordx4 v[124:127], v2, s[48:51], s3 offen sc1
    ds_write_b128 v10, v[168:171]
    ds_write_b128 v10, v[172:175] offset:1280
    ds_read_b64 v[176:177], v11 offset:0
    ds_read_b64 v[178:179], v11 offset:16
    ds_read_b64 v[180:181], v11 offset:32
    ds_read_b64 v[182:183], v11 offset:48
    s_waitcnt lgkmcnt(10)
    v_mfma_f32_32x32x16_bf16 v[16:31], v[128:131], v[80:83], v[16:31]
    ds_read_b64_tr_b16 v[152:153], v148 offset:0
    ds_read_b64_tr_b16 v[154:155], v148 offset:1024
    v_mfma_f32_32x32x16_bf16 v[32:47], v[132:135], v[80:83], v[32:47]
    s_add_u32 s3, s88, 5120
    buffer_load_dwordx4 v[80:83], v2, s[48:51], s3 offen sc1
    v_mfma_f32_32x32x16_bf16 v[48:63], v[128:131], v[84:87], v[48:63]
    ds_read_b64_tr_b16 v[156:157], v149 offset:0
    ds_read_b64_tr_b16 v[158:159], v149 offset:1024
    v_mfma_f32_32x32x16_bf16 v[64:79], v[132:135], v[84:87], v[64:79]
    s_add_u32 s3, s89, 5120
    buffer_load_dwordx4 v[84:87], v2, s[48:51], s3 offen sc1
    s_waitcnt vmcnt(10) lgkmcnt(10)
    v_mfma_f32_32x32x16_bf16 v[16:31], v[136:139], v[88:91], v[16:31]
    ds_read_b64_tr_b16 v[128:129], v148 offset:2048
    ds_read_b64_tr_b16 v[130:131], v148 offset:3072
    v_mfma_f32_32x32x16_bf16 v[32:47], v[140:143], v[88:91], v[32:47]
    s_add_u32 s3, s88, 29696
    buffer_load_dwordx4 v[88:91], v2, s[48:51], s3 offen sc1
    v_mfma_f32_32x32x16_bf16 v[48:63], v[136:139], v[92:95], v[48:63]
    ds_read_b64_tr_b16 v[132:133], v149 offset:2048
    ds_read_b64_tr_b16 v[134:135], v149 offset:3072
    v_mfma_f32_32x32x16_bf16 v[64:79], v[140:143], v[92:95], v[64:79]
    s_add_u32 s3, s89, 29696
    buffer_load_dwordx4 v[92:95], v2, s[48:51], s3 offen sc1
    s_waitcnt vmcnt(10) lgkmcnt(4)
    v_mfma_f32_32x32x16_bf16 v[16:31], v[152:155], v[96:99], v[16:31]
    ds_read_b64_tr_b16 v[136:137], v150 offset:0
    ds_read_b64_tr_b16 v[138:139], v150 offset:1024
    v_mfma_f32_32x32x16_bf16 v[32:47], v[156:159], v[96:99], v[32:47]
    s_add_u32 s3, s88, 54272
    buffer_load_dwordx4 v[96:99], v2, s[48:51], s3 offen sc1
    v_mfma_f32_32x32x16_bf16 v[48:63], v[152:155], v[100:103], v[48:63]
    ds_read_b64_tr_b16 v[140:141], v151 offset:0
    ds_read_b64_tr_b16 v[142:143], v151 offset:1024
    v_mfma_f32_32x32x16_bf16 v[64:79], v[156:159], v[100:103], v[64:79]
    s_add_u32 s3, s89, 54272
    buffer_load_dwordx4 v[100:103], v2, s[48:51], s3 offen sc1
    s_waitcnt vmcnt(10) lgkmcnt(4)
    v_mfma_f32_32x32x16_bf16 v[16:31], v[128:131], v[104:107], v[16:31]
    ds_read_b64_tr_b16 v[152:153], v150 offset:2048
    ds_read_b64_tr_b16 v[154:155], v148 offset:16384
    v_mfma_f32_32x32x16_bf16 v[32:47], v[132:135], v[104:107], v[32:47]
    s_add_u32 s3, s88, 78848
    s_cmp_ge_u32 s60, 2
    s_cselect_b32 s101, 268435456, 0
    s_add_u32 s3, s3, s101
    buffer_load_dwordx4 v[104:107], v2, s[48:51], s3 offen sc1
    v_mfma_f32_32x32x16_bf16 v[48:63], v[128:131], v[108:111], v[48:63]
    ds_read_b64_tr_b16 v[156:157], v151 offset:2048
    ds_read_b64_tr_b16 v[158:159], v149 offset:16384
    v_mfma_f32_32x32x16_bf16 v[64:79], v[132:135], v[108:111], v[64:79]
    s_add_u32 s3, s89, 78848
    s_cmp_ge_u32 s60, 2
    s_cselect_b32 s101, 268435456, 0
    s_add_u32 s3, s3, s101
    buffer_load_dwordx4 v[108:111], v2, s[48:51], s3 offen sc1
    buffer_load_dword v14, v5, s[48:51], 0 offen sc1
    s_waitcnt vmcnt(11) lgkmcnt(4)
    v_mfma_f32_32x32x16_bf16 v[16:31], v[136:139], v[112:115], v[16:31]
    ds_read_b64_tr_b16 v[128:129], v148 offset:17408
    ds_read_b64_tr_b16 v[130:131], v148 offset:18432
    v_mfma_f32_32x32x16_bf16 v[32:47], v[140:143], v[112:115], v[32:47]
    v_mfma_f32_32x32x16_bf16 v[48:63], v[136:139], v[116:119], v[48:63]
    ds_read_b64_tr_b16 v[132:133], v149 offset:17408
    ds_read_b64_tr_b16 v[134:135], v149 offset:18432
    v_mfma_f32_32x32x16_bf16 v[64:79], v[140:143], v[116:119], v[64:79]
    s_waitcnt vmcnt(9) lgkmcnt(4)
    v_mfma_f32_32x32x16_bf16 v[16:31], v[152:155], v[120:123], v[16:31]
    ds_read_b64_tr_b16 v[136:137], v148 offset:19456
    ds_read_b64_tr_b16 v[138:139], v150 offset:12288
    v_mfma_f32_32x32x16_bf16 v[32:47], v[156:159], v[120:123], v[32:47]
    v_mfma_f32_32x32x16_bf16 v[48:63], v[152:155], v[124:127], v[48:63]
    ds_read_b64_tr_b16 v[140:141], v149 offset:19456
    ds_read_b64_tr_b16 v[142:143], v151 offset:12288
    v_mfma_f32_32x32x16_bf16 v[64:79], v[156:159], v[124:127], v[64:79]
    s_waitcnt vmcnt(7) lgkmcnt(4)
    v_mfma_f32_32x32x16_bf16 v[16:31], v[128:131], v[80:83], v[16:31]
    ds_read_b64_tr_b16 v[152:153], v150 offset:13312
    ds_read_b64_tr_b16 v[154:155], v150 offset:14336
    v_mfma_f32_32x32x16_bf16 v[32:47], v[132:135], v[80:83], v[32:47]
    v_mfma_f32_32x32x16_bf16 v[48:63], v[128:131], v[84:87], v[48:63]
    ds_read_b64_tr_b16 v[156:157], v151 offset:13312
    ds_read_b64_tr_b16 v[158:159], v151 offset:14336
    v_mfma_f32_32x32x16_bf16 v[64:79], v[132:135], v[84:87], v[64:79]
    s_waitcnt vmcnt(5) lgkmcnt(4)
    v_mfma_f32_32x32x16_bf16 v[16:31], v[136:139], v[88:91], v[16:31]
    ds_read_b64_tr_b16 v[128:129], v148 offset:32768
    ds_read_b64_tr_b16 v[130:131], v148 offset:33792
    v_mfma_f32_32x32x16_bf16 v[32:47], v[140:143], v[88:91], v[32:47]
    v_mfma_f32_32x32x16_bf16 v[48:63], v[136:139], v[92:95], v[48:63]
    ds_read_b64_tr_b16 v[132:133], v149 offset:32768
    ds_read_b64_tr_b16 v[134:135], v149 offset:33792
    v_mfma_f32_32x32x16_bf16 v[64:79], v[140:143], v[92:95], v[64:79]
    s_waitcnt vmcnt(0)
    v_cmp_ne_u32 vcc, v147, v14
    s_mov_b32 s87, 0
    s_cmp_eq_u64 vcc, 0
    s_cbranch_scc1 Lok_26
Lspin_27:
    buffer_load_dword v14, v5, s[48:51], 0 offen sc1
    s_add_u32 s87, s87, 1
    s_waitcnt vmcnt(0)
    v_cmp_ne_u32 vcc, v147, v14
    s_cmp_gt_u32 s87, 262144
    s_cbranch_scc1 Lok_26
    s_cmp_eq_u64 vcc, 0
    s_cbranch_scc0 Lspin_27
Lok_26:
    s_add_u32 s90, s76, 65536
    buffer_load_dwordx4 v[168:171], v9, s[48:51], s76 offen sc1
    buffer_load_dwordx4 v[172:175], v9, s[48:51], s90 offen sc1
    s_waitcnt lgkmcnt(4)
    v_mfma_f32_32x32x16_bf16 v[16:31], v[152:155], v[96:99], v[16:31]
    v_mfma_f32_32x32x16_bf16 v[32:47], v[156:159], v[96:99], v[32:47]
    v_mfma_f32_32x32x16_bf16 v[48:63], v[152:155], v[100:103], v[48:63]
    v_mfma_f32_32x32x16_bf16 v[64:79], v[156:159], v[100:103], v[64:79]
    s_waitcnt lgkmcnt(0)
    v_mfma_f32_32x32x16_bf16 v[16:31], v[128:131], v[104:107], v[16:31]
    v_mfma_f32_32x32x16_bf16 v[32:47], v[132:135], v[104:107], v[32:47]
    v_mfma_f32_32x32x16_bf16 v[48:63], v[128:131], v[108:111], v[48:63]
    v_mfma_f32_32x32x16_bf16 v[64:79], v[132:135], v[108:111], v[64:79]
    v_lshlrev_b32 v80, 16, v176
    v_and_b32 v81, 0xffff0000, v176
    v_lshlrev_b32 v82, 16, v177
    v_and_b32 v83, 0xffff0000, v177
    v_lshlrev_b32 v84, 16, v178
    v_and_b32 v85, 0xffff0000, v178
    v_lshlrev_b32 v86, 16, v179
    v_and_b32 v87, 0xffff0000, v179
    v_lshlrev_b32 v88, 16, v180
    v_and_b32 v89, 0xffff0000, v180
    v_lshlrev_b32 v90, 16, v181
    v_and_b32 v91, 0xffff0000, v181
    v_lshlrev_b32 v92, 16, v182
    v_and_b32 v93, 0xffff0000, v182
    v_lshlrev_b32 v94, 16, v183
    v_and_b32 v95, 0xffff0000, v183
    ds_write_b128 v184, v[32:35] offset:0
    ds_write_b128 v184, v[36:39] offset:1024
    ds_write_b128 v184, v[40:43] offset:2048
    ds_write_b128 v184, v[44:47] offset:3072
    ds_write_b128 v184, v[48:51] offset:16384
    ds_write_b128 v184, v[52:55] offset:17408
    ds_write_b128 v184, v[56:59] offset:18432
    ds_write_b128 v184, v[60:63] offset:19456
    ds_write_b128 v184, v[64:67] offset:32768
    ds_write_b128 v184, v[68:71] offset:33792
    ds_write_b128 v184, v[72:75] offset:34816
    ds_write_b128 v184, v[76:79] offset:35840
    s_waitcnt vmcnt(0)
    ds_write_b128 v12, v[168:171]
    ds_write_b128 v12, v[172:175] offset:1024
    ds_read_b64_tr_b16 v[160:161], v13 offset:0
    ds_read_b64_tr_b16 v[162:163], v13 offset:512
    ds_read_b64_tr_b16 v[164:165], v13 offset:1024
    ds_read_b64_tr_b16 v[166:167], v13 offset:1536
    s_mov_b32 s84, 0xbfb8aa3b
    s_waitcnt lgkmcnt(0)
    s_barrier
    ds_read_b128 v[32:35], v185 offset:0
    ds_read_b128 v[48:51], v186 offset:16384
    ds_read_b128 v[64:67], v187 offset:32768
    ds_read_b128 v[36:39], v185 offset:1024
    ds_read_b128 v[52:55], v186 offset:17408
    ds_read_b128 v[68:71], v187 offset:33792
    ds_read_b128 v[40:43], v185 offset:2048
    ds_read_b128 v[56:59], v186 offset:18432
    ds_read_b128 v[72:75], v187 offset:34816
    ds_read_b128 v[44:47], v185 offset:3072
    ds_read_b128 v[60:63], v186 offset:19456
    ds_read_b128 v[76:79], v187 offset:35840
    v_lshlrev_b32 v96, 16, v160
    v_and_b32 v97, 0xffff0000, v160
    v_lshlrev_b32 v98, 16, v161
    v_and_b32 v99, 0xffff0000, v161
    v_lshlrev_b32 v100, 16, v162
    v_and_b32 v101, 0xffff0000, v162
    v_lshlrev_b32 v102, 16, v163
    v_and_b32 v103, 0xffff0000, v163
    v_lshlrev_b32 v104, 16, v164
    v_and_b32 v105, 0xffff0000, v164
    v_lshlrev_b32 v106, 16, v165
    v_and_b32 v107, 0xffff0000, v165
    v_lshlrev_b32 v108, 16, v166
    v_and_b32 v109, 0xffff0000, v166
    v_lshlrev_b32 v110, 16, v167
    v_and_b32 v111, 0xffff0000, v167
    s_waitcnt lgkmcnt(9)
    v_pk_add_f32 v[16:17], v[16:17], v[32:33]
    v_pk_add_f32 v[18:19], v[18:19], v[34:35]
    v_pk_add_f32 v[48:49], v[48:49], v[64:65]
    v_pk_add_f32 v[50:51], v[50:51], v[66:67]
    v_pk_add_f32 v[16:17], v[16:17], v[48:49]
    v_pk_add_f32 v[18:19], v[18:19], v[50:51]
    v_pk_mul_f32 v[112:113], v[16:17], s[84:85] op_sel_hi:[1,0]
    v_pk_mul_f32 v[114:115], v[18:19], s[84:85] op_sel_hi:[1,0]
    v_exp_f32 v112, v112
    v_exp_f32 v113, v113
    v_exp_f32 v114, v114
    v_exp_f32 v115, v115
    v_pk_mul_f32 v[16:17], v[16:17], v[96:97]
    v_pk_mul_f32 v[18:19], v[18:19], v[98:99]
    v_pk_add_f32 v[112:113], v[112:113], 1.0 op_sel_hi:[1,0]
    v_pk_add_f32 v[114:115], v[114:115], 1.0 op_sel_hi:[1,0]
    v_rcp_f32 v112, v112
    v_rcp_f32 v113, v113
    v_rcp_f32 v114, v114
    v_rcp_f32 v115, v115
    v_pk_fma_f32 v[112:113], v[112:113], v[16:17], v[80:81]
    v_pk_fma_f32 v[114:115], v[114:115], v[18:19], v[82:83]
    v_cvt_pk_bf16_f32 v128, v112, v113
    v_cvt_pk_bf16_f32 v129, v114, v115
    s_waitcnt lgkmcnt(6)
    v_pk_add_f32 v[20:21], v[20:21], v[36:37]
    v_pk_add_f32 v[22:23], v[22:23], v[38:39]
    v_pk_add_f32 v[52:53], v[52:53], v[68:69]
    v_pk_add_f32 v[54:55], v[54:55], v[70:71]
    v_pk_add_f32 v[20:21], v[20:21], v[52:53]
    v_pk_add_f32 v[22:23], v[22:23], v[54:55]
    v_pk_mul_f32 v[116:117], v[20:21], s[84:85] op_sel_hi:[1,0]
    v_pk_mul_f32 v[118:119], v[22:23], s[84:85] op_sel_hi:[1,0]
    v_exp_f32 v116, v116
    v_exp_f32 v117, v117
    v_exp_f32 v118, v118
    v_exp_f32 v119, v119
    v_pk_mul_f32 v[20:21], v[20:21], v[100:101]
    v_pk_mul_f32 v[22:23], v[22:23], v[102:103]
    v_pk_add_f32 v[116:117], v[116:117], 1.0 op_sel_hi:[1,0]
    v_pk_add_f32 v[118:119], v[118:119], 1.0 op_sel_hi:[1,0]
    v_rcp_f32 v116, v116
    v_rcp_f32 v117, v117
    v_rcp_f32 v118, v118
    v_rcp_f32 v119, v119
    v_pk_fma_f32 v[116:117], v[116:117], v[20:21], v[84:85]
    v_pk_fma_f32 v[118:119], v[118:119], v[22:23], v[86:87]
    v_cvt_pk_bf16_f32 v130, v116, v117
    v_cvt_pk_bf16_f32 v131, v118, v119
    s_nop 0
    v_permlane32_swap_b32 v128, v130
    v_permlane32_swap_b32 v129, v131
    buffer_store_dwordx4 v[128:131], v7, s[52:55], s79 offen offset:0
    s_waitcnt lgkmcnt(3)
    v_pk_add_f32 v[24:25], v[24:25], v[40:41]
    v_pk_add_f32 v[26:27], v[26:27], v[42:43]
    v_pk_add_f32 v[56:57], v[56:57], v[72:73]
    v_pk_add_f32 v[58:59], v[58:59], v[74:75]
    v_pk_add_f32 v[24:25], v[24:25], v[56:57]
    v_pk_add_f32 v[26:27], v[26:27], v[58:59]
    v_pk_mul_f32 v[120:121], v[24:25], s[84:85] op_sel_hi:[1,0]
    v_pk_mul_f32 v[122:123], v[26:27], s[84:85] op_sel_hi:[1,0]
    v_exp_f32 v120, v120
    v_exp_f32 v121, v121
    v_exp_f32 v122, v122
    v_exp_f32 v123, v123
    v_pk_mul_f32 v[24:25], v[24:25], v[104:105]
    v_pk_mul_f32 v[26:27], v[26:27], v[106:107]
    v_pk_add_f32 v[120:121], v[120:121], 1.0 op_sel_hi:[1,0]
    v_pk_add_f32 v[122:123], v[122:123], 1.0 op_sel_hi:[1,0]
    v_rcp_f32 v120, v120
    v_rcp_f32 v121, v121
    v_rcp_f32 v122, v122
    v_rcp_f32 v123, v123
    v_pk_fma_f32 v[120:121], v[120:121], v[24:25], v[88:89]
    v_pk_fma_f32 v[122:123], v[122:123], v[26:27], v[90:91]
    v_cvt_pk_bf16_f32 v132, v120, v121
    v_cvt_pk_bf16_f32 v133, v122, v123
    s_waitcnt lgkmcnt(0)
    v_pk_add_f32 v[28:29], v[28:29], v[44:45]
    v_pk_add_f32 v[30:31], v[30:31], v[46:47]
    v_pk_add_f32 v[60:61], v[60:61], v[76:77]
    v_pk_add_f32 v[62:63], v[62:63], v[78:79]
    v_pk_add_f32 v[28:29], v[28:29], v[60:61]
    v_pk_add_f32 v[30:31], v[30:31], v[62:63]
    v_pk_mul_f32 v[124:125], v[28:29], s[84:85] op_sel_hi:[1,0]
    v_pk_mul_f32 v[126:127], v[30:31], s[84:85] op_sel_hi:[1,0]
    v_exp_f32 v124, v124
    v_exp_f32 v125, v125
    v_exp_f32 v126, v126
    v_exp_f32 v127, v127
    v_pk_mul_f32 v[28:29], v[28:29], v[108:109]
    v_pk_mul_f32 v[30:31], v[30:31], v[110:111]
    v_pk_add_f32 v[124:125], v[124:125], 1.0 op_sel_hi:[1,0]
    v_pk_add_f32 v[126:127], v[126:127], 1.0 op_sel_hi:[1,0]
    v_rcp_f32 v124, v124
    v_rcp_f32 v125, v125
    v_rcp_f32 v126, v126
    v_rcp_f32 v127, v127
    v_pk_fma_f32 v[124:125], v[124:125], v[28:29], v[92:93]
    v_pk_fma_f32 v[126:127], v[126:127], v[30:31], v[94:95]
    v_cvt_pk_bf16_f32 v134, v124, v125
    v_cvt_pk_bf16_f32 v135, v126, v127
    s_nop 0
    v_permlane32_swap_b32 v132, v134
    v_permlane32_swap_b32 v133, v135
    buffer_store_dwordx4 v[132:135], v7, s[52:55], s79 offen offset:32
    s_endpgm
Lend:
    s_endpgm
Lcodeend:
.section .rodata,"a"
.p2align 6
.amdhsa_kernel recurrent_scan__ssm_conv_s4d__mixer_channel_mlp__prompt_kernel
  .amdhsa_next_free_vgpr 256
  .amdhsa_next_free_sgpr 102
  .amdhsa_accum_offset 192
  .amdhsa_group_segment_fixed_size 0
  .amdhsa_kernarg_size 120
  .amdhsa_user_sgpr_count 2
  .amdhsa_user_sgpr_kernarg_segment_ptr 1
  .amdhsa_system_sgpr_workgroup_id_x 1
.end_amdhsa_kernel
```
